```python
import torch

def _softmax(x, axis=-1):
    return torch.softmax(x, dim=axis)
def _gelu(x):
    return torch.nn.functional.gelu(x, approximate="tanh")
def _silu(x):
    return torch.nn.functional.silu(x)
def _sigmoid(x):
    return torch.sigmoid(x)
def _layernorm(x, axis=-1, eps=1e-5):
    m = x.mean(dim=axis, keepdim=True)
    v = x.var(dim=axis, keepdim=True, unbiased=False)
    return (x - m) / torch.sqrt(v + eps)
def _scatter_add(tgt, idx, src, axis=0):
    return tgt.clone().index_add_(axis, idx, src)
def _segment_sum(src, seg, n):
    out = torch.zeros((n,) + src.shape[1:], dtype=src.dtype)
    return out.index_add_(0, seg, src)
def _pad(x, pw):
    flat = tuple(v for pair in reversed(pw) for v in pair)
    return torch.nn.functional.pad(x, flat)

kernel_name = 'standalone__deep_cross_wide_deep__recsys'

def setup_inputs():

    _w = (lambda a: (lambda t: t.to(torch.bfloat16) if t.is_floating_point() else t)(torch.as_tensor(a)))
    B, F, D = 4096, 26, 128
    V, Nd = min(100000, 100000), 13
    Din = F * D
    H = 4 * D
    return {
        "idx": _w((lambda lo, hi, *s: torch.randint(lo, hi, s))(0, V, B, F).to(torch.int64)),
        "table": _w((lambda *s: torch.randn(*s, dtype=torch.bfloat16) * 1.6)(V, D) * 0.05),
        "x_wide": _w((lambda *s: torch.randn(*s, dtype=torch.bfloat16) * 0.8)(B, Nd)),
        "w_wide": _w((lambda *s: torch.randn(*s, dtype=torch.bfloat16) * 0.8)(Nd) * 0.05),
        "b_wide": _w((lambda *s: torch.randn(*s, dtype=torch.bfloat16) * 0.8)(1) * 0.01),
        "W1": _w((lambda *s: torch.randn(*s, dtype=torch.bfloat16) * 1.6)(Din, H) * (2.0 / Din) ** 0.5),
        "b1": _w((lambda *s: torch.randn(*s, dtype=torch.bfloat16) * 1.6)(H) * 0.01),
        "W2": _w((lambda *s: torch.randn(*s, dtype=torch.bfloat16) * 1.6)(H) * (1.0 / H) ** 0.5),
        "b2": _w((lambda *s: torch.randn(*s, dtype=torch.bfloat16) * 1.6)(1) * 0.01),
    }

def reference(idx, table, x_wide, w_wide, b_wide, W1, b1, W2, b2):
    emb = table[idx]
    deep_in = emb.reshape(emb.shape[0], -1)
    h = deep_in @ W1 + b1
    h = h * (lambda x, dt: x.to(dt))(h > 0, h.dtype)
    deep_logit = h @ W2 + b2
    wide_logit = x_wide @ w_wide + b_wide
    return _sigmoid(wide_logit + deep_logit)
```

```asm
; @launch grid=(256,1,1) block=(320,1,1) lds=163840
.amdgcn_target "amdgcn-amd-amdhsa--gfx950"
.text
.globl standalone__deep_cross_wide_deep__recsys_kernel
.p2align 8
.type standalone__deep_cross_wide_deep__recsys_kernel,@function
standalone__deep_cross_wide_deep__recsys_kernel:
    s_cmp_ge_u32 s2, 256
    s_cbranch_scc1 L_end
    s_load_dwordx16 s[16:31], s[0:1], 0
    s_load_dwordx8 s[32:39], s[0:1], 64
    v_and_b32 v27, 63, v0
    v_lshrrev_b32 v28, 6, v0
    s_and_b32 s3, s2, 7
    v_readfirstlane_b32 s5, v28
    s_lshl_b32 s3, s3, 3
    s_lshr_b32 s14, s2, 3
    s_and_b32 s8, s14, 7
    s_add_u32 s3, s3, s8
    s_lshr_b32 s4, s2, 6
    s_and_b32 s8, s2, 7
    s_lshl_b32 s8, s8, 2
    s_lshr_b32 s61, 0xba875320, s8
    s_and_b32 s61, s61, 15
    s_cmp_eq_u32 s5, 4
    s_cbranch_scc1 L_helper
    s_add_u32 s8, s14, s4
    s_and_b32 s8, s8, 3
    s_mov_b32 s62, 0x86534210
    s_mov_b32 s63, 0x2bca97
    s_cmp_eq_u32 s8, 1
    s_cselect_b32 s62, 0x76453201, s62
    s_cselect_b32 s63, 0x3cba89, s63
    s_cmp_eq_u32 s8, 2
    s_cselect_b32 s62, 0x75643120, s62
    s_cselect_b32 s63, 0x4cb9a8, s63
    s_cmp_eq_u32 s8, 3
    s_cselect_b32 s62, 0x67542310, s62
    s_cselect_b32 s63, 0x1cab98, s63
    s_mul_i32 s6, s5, 36864
    s_add_u32 s6, s6, 8192
    s_lshr_b32 s9, s5, 1
    s_and_b32 s10, s5, 1
    s_mul_i32 s8, s3, 6656
    s_lshl_b32 s12, s5, 11
    s_add_u32 s8, s8, s12
    v_lshlrev_b32 v31, 4, v27
    v_add_u32 v31, s8, v31
    s_mov_b32 m0, s12
    s_mul_i32 s7, s9, 1703936
    s_lshl_b32 s8, s10, 16
    s_add_u32 s7, s7, s8
    s_lshl_b32 s8, s4, 1
    s_add_u32 s8, s8, s9
    s_lshl_b32 s8, s8, 2
    s_lshr_b32 s78, 0x76543210, s8
    s_and_b32 s78, s78, 7
    s_lshl_b32 s78, s78, 7
    s_add_u32 s78, s78, s7
    s_xor_b32 s8, s8, 4
    s_lshr_b32 s79, 0x76543210, s8
    s_and_b32 s79, s79, 7
    s_lshl_b32 s79, s79, 7
    s_add_u32 s79, s79, s7
    s_mul_i32 s11, s9, 52
    v_lshrrev_b32 v28, 4, v27
    v_and_b32 v29, 1, v28
    v_lshlrev_b32 v29, 1, v29
    v_and_b32 v30, 7, v27
    v_xor_b32 v29, v29, v30
    v_lshlrev_b32 v29, 4, v29
    v_lshrrev_b32 v7, 3, v27
    v_lshl_add_u32 v12, v7, 10, v29
    v_add_u32 v14, 14336, v12
    v_xor_b32 v29, 64, v12
    v_add_u32 v13, 7168, v29
    v_add_u32 v15, 21504, v29
    s_lshl_b32 s8, s3, 2
    s_add_u32 s8, s8, s4
    s_lshl_b32 s8, s8, 9
    v_lshlrev_b32 v25, 3, v27
    v_add_u32 v25, s8, v25
    s_bfe_u32 s64, s62, 0x40000
    s_add_u32 s64, s64, s61
    s_sub_u32 s8, s64, 13
    s_cselect_b32 s64, s64, s8
    s_bfe_u32 s65, s62, 0x40004
    s_add_u32 s65, s65, s61
    s_sub_u32 s8, s65, 13
    s_cselect_b32 s65, s65, s8
    v_mul_u32_u24 v7, 104, v7
    v_add_u32 v7, s11, v7
    s_mul_i32 s8, s3, 6656
    s_lshl_b32 s13, s64, 2
    s_add_u32 s80, s8, s13
    s_add_u32 s81, s80, 3328
    s_waitcnt lgkmcnt(0)
    s_mov_b32 s40, s16
    s_and_b32 s41, s17, 0xffff
    s_mov_b32 s42, 425984
    s_mov_b32 s43, 0x20000
    buffer_load_dwordx4 v31, s[40:43], 0 offen lds
    s_cmp_eq_u32 s5, 3
    s_cbranch_scc1 L_i7
    buffer_load_dwordx4 v31, s[40:43], 0 offen offset:1024 lds
L_i7:
    s_mov_b32 s48, s26
    s_and_b32 s49, s27, 0xffff
    s_mov_b32 s50, 3407872
    s_mov_b32 s51, 0x20000
    s_mov_b32 s52, s38
    s_and_b32 s53, s39, 0xffff
    s_mov_b32 s54, 131072
    s_mov_b32 s55, 0x20000
    s_mov_b32 s56, s36
    s_and_b32 s57, s37, 0xffff
    s_mov_b32 s58, 256
    s_mov_b32 s59, 0x20000
    s_bfe_u32 s77, s63, 0x40014
    s_cmp_eq_u32 s5, 0
    s_cselect_b32 s77, s77, 15
    s_lshl_b32 s15, s3, 2
    s_add_u32 s13, s15, s4
    s_barrier
    s_add_u32 m0, s6, 0
    s_lshl_b32 s8, s64, 17
    s_add_u32 s8, s8, s79
    buffer_load_dwordx4 v12, s[48:51], s8 offen offset:0 lds
    buffer_load_dwordx4 v13, s[48:51], s8 offen offset:1024 lds
    buffer_load_dwordx4 v14, s[48:51], s8 offen offset:2048 lds
    buffer_load_dwordx4 v15, s[48:51], s8 offen offset:3072 lds
    s_add_u32 m0, s6, 4096
    s_lshl_b32 s8, s64, 17
    s_add_u32 s8, s8, s79
    s_add_u32 s8, s8, 32768
    buffer_load_dwordx4 v12, s[48:51], s8 offen offset:0 lds
    buffer_load_dwordx4 v13, s[48:51], s8 offen offset:1024 lds
    buffer_load_dwordx4 v14, s[48:51], s8 offen offset:2048 lds
    buffer_load_dwordx4 v15, s[48:51], s8 offen offset:3072 lds
    v_xor_b32 v29, v30, v28
    v_lshlrev_b32 v29, 4, v29
    s_lshl_b32 s8, s10, 7
    v_add_u32 v29, s8, v29
    v_add_u32 v8, 3072, v29
    v_add_u32 v10, 1024, v29
    v_xor_b32 v29, 64, v29
    v_add_u32 v9, 2048, v29
    v_mov_b32 v11, v29
    s_sub_u32 s44, s18, 3072
    s_subb_u32 s45, s19, 0
    s_and_b32 s45, s45, 0xffff
    s_mov_b32 s46, 25603072
    s_mov_b32 s47, 0x20000
    s_bfe_u32 s66, s62, 0x40008
    s_add_u32 s66, s66, s61
    s_sub_u32 s8, s66, 13
    s_cselect_b32 s66, s66, s8
    s_bfe_u32 s67, s62, 0x4000c
    s_add_u32 s67, s67, s61
    s_sub_u32 s8, s67, 13
    s_cselect_b32 s67, s67, s8
    s_bfe_u32 s68, s62, 0x40010
    s_add_u32 s68, s68, s61
    s_sub_u32 s8, s68, 13
    s_cselect_b32 s68, s68, s8
    s_bfe_u32 s69, s62, 0x40014
    s_add_u32 s69, s69, s61
    s_sub_u32 s8, s69, 13
    s_cselect_b32 s69, s69, s8
    s_bfe_u32 s70, s62, 0x40018
    s_add_u32 s70, s70, s61
    s_sub_u32 s8, s70, 13
    s_cselect_b32 s70, s70, s8
    s_bfe_u32 s71, s62, 0x4001c
    s_add_u32 s71, s71, s61
    s_sub_u32 s8, s71, 13
    s_cselect_b32 s71, s71, s8
    s_bfe_u32 s72, s63, 0x40000
    s_add_u32 s72, s72, s61
    s_sub_u32 s8, s72, 13
    s_cselect_b32 s72, s72, s8
    s_bfe_u32 s73, s63, 0x40004
    s_add_u32 s73, s73, s61
    s_sub_u32 s8, s73, 13
    s_cselect_b32 s73, s73, s8
    s_bfe_u32 s74, s63, 0x40008
    s_add_u32 s74, s74, s61
    s_sub_u32 s8, s74, 13
    s_cselect_b32 s74, s74, s8
    s_bfe_u32 s75, s63, 0x4000c
    s_add_u32 s75, s75, s61
    s_sub_u32 s8, s75, 13
    s_cselect_b32 s75, s75, s8
    s_bfe_u32 s76, s63, 0x40010
    s_add_u32 s76, s76, s61
    s_sub_u32 s8, s76, 13
    s_cselect_b32 s76, s76, s8
    s_mov_b32 s84, s34
    s_and_b32 s85, s35, 0xffff
    s_mov_b32 s86, 8192
    s_mov_b32 s87, 0x20000
    v_and_b32 v29, 15, v27
    v_lshrrev_b32 v30, 1, v29
    v_xor_b32 v30, v30, v28
    v_lshlrev_b32 v30, 4, v30
    v_lshl_add_u32 v30, v29, 7, v30
    v_add_u32 v1, s6, v30
    v_xor_b32 v30, 64, v30
    v_add_u32 v2, s6, v30
    v_lshrrev_b32 v29, 2, v27
    v_and_b32 v29, 3, v29
    v_lshl_add_u32 v30, v28, 3, v29
    v_lshlrev_b32 v30, 7, v30
    v_lshrrev_b32 v29, 1, v29
    v_and_b32 v31, 1, v28
    v_lshl_add_u32 v29, v31, 1, v29
    s_lshl_b32 s8, s10, 1
    v_xor_b32 v29, s8, v29
    v_lshl_add_u32 v30, v29, 5, v30
    v_and_b32 v29, 3, v27
    v_lshl_add_u32 v30, v29, 3, v30
    v_xor_b32 v3, 0, v30
    v_add_u32 v3, s6, v3
    v_xor_b32 v4, 32, v30
    v_add_u32 v4, s6, v4
    v_xor_b32 v5, 64, v30
    v_add_u32 v5, s6, v5
    v_xor_b32 v6, 96, v30
    v_add_u32 v6, s6, v6
    s_waitcnt vmcnt(8)
    s_barrier
    v_mov_b32 v24, 1
    s_lshl_b32 s9, s64, 2
    v_add_u32 v30, s9, v7
    ds_read_b32 v16, v30 offset:0
    ds_read_b32 v17, v30 offset:832
    ds_read_b32 v18, v30 offset:1664
    ds_read_b32 v19, v30 offset:2496
    s_lshl_b32 s9, s64, 2
    v_add_u32 v30, s9, v7
    ds_read_b32 v20, v30 offset:3328
    ds_read_b32 v21, v30 offset:4160
    ds_read_b32 v22, v30 offset:4992
    ds_read_b32 v23, v30 offset:5824
    s_waitcnt lgkmcnt(4)
    v_lshl_add_u32 v16, v16, 8, v8
    v_lshl_add_u32 v17, v17, 8, v9
    v_lshl_add_u32 v18, v18, 8, v10
    v_lshl_add_u32 v19, v19, 8, v11
    s_add_u32 m0, s6, 28672
    s_nop 0
    buffer_load_dwordx4 v16, s[44:47], 0 offen offset:0  lds
    buffer_load_dwordx4 v17, s[44:47], 0 offen offset:1024  lds
    buffer_load_dwordx4 v18, s[44:47], 0 offen offset:2048  lds
    buffer_load_dwordx4 v19, s[44:47], 0 offen offset:3072  lds
    s_lshl_b32 s9, s65, 2
    v_add_u32 v30, s9, v7
    ds_read_b32 v16, v30 offset:0
    ds_read_b32 v17, v30 offset:832
    ds_read_b32 v18, v30 offset:1664
    ds_read_b32 v19, v30 offset:2496
    s_waitcnt lgkmcnt(4)
    v_lshl_add_u32 v20, v20, 8, v8
    v_lshl_add_u32 v21, v21, 8, v9
    v_lshl_add_u32 v22, v22, 8, v10
    v_lshl_add_u32 v23, v23, 8, v11
    s_add_u32 m0, s6, 32768
    s_nop 0
    buffer_load_dwordx4 v20, s[44:47], 0 offen offset:0  lds
    buffer_load_dwordx4 v21, s[44:47], 0 offen offset:1024  lds
    buffer_load_dwordx4 v22, s[44:47], 0 offen offset:2048  lds
    buffer_load_dwordx4 v23, s[44:47], 0 offen offset:3072  lds
    s_lshl_b32 s9, s65, 2
    v_add_u32 v30, s9, v7
    ds_read_b32 v20, v30 offset:3328
    ds_read_b32 v21, v30 offset:4160
    ds_read_b32 v22, v30 offset:4992
    ds_read_b32 v23, v30 offset:5824
    s_add_u32 m0, s6, 8192
    s_lshl_b32 s8, s64, 17
    s_add_u32 s8, s8, s78
    buffer_load_dwordx4 v12, s[48:51], s8 offen offset:0 lds
    buffer_load_dwordx4 v13, s[48:51], s8 offen offset:1024 lds
    buffer_load_dwordx4 v14, s[48:51], s8 offen offset:2048 lds
    buffer_load_dwordx4 v15, s[48:51], s8 offen offset:3072 lds
    s_add_u32 m0, s6, 12288
    s_lshl_b32 s8, s64, 17
    s_add_u32 s8, s8, s78
    s_add_u32 s8, s8, 32768
    buffer_load_dwordx4 v12, s[48:51], s8 offen offset:0 lds
    buffer_load_dwordx4 v13, s[48:51], s8 offen offset:1024 lds
    buffer_load_dwordx4 v14, s[48:51], s8 offen offset:2048 lds
    buffer_load_dwordx4 v15, s[48:51], s8 offen offset:3072 lds
    s_cmp_lg_u32 s5, 0
    s_cbranch_scc1 L_nclr
    v_mov_b32 v128, -1
    v_mov_b32 v129, -1
    buffer_store_dwordx2 v[128:129], v25, s[52:55], 0 offen sc1
L_nclr:
    s_waitcnt vmcnt(20)
    ds_read_b64_tr_b16 v[32:33], v3 offset:0
    ds_read_b64_tr_b16 v[34:35], v3 offset:512
    ds_read_b64_tr_b16 v[36:37], v4 offset:0
    ds_read_b64_tr_b16 v[38:39], v4 offset:512
    ds_read_b64_tr_b16 v[40:41], v5 offset:0
    ds_read_b64_tr_b16 v[42:43], v5 offset:512
    ds_read_b64_tr_b16 v[44:45], v6 offset:0
    s_waitcnt lgkmcnt(11)
    ds_read_b64_tr_b16 v[46:47], v6 offset:512
    s_waitcnt vmcnt(12)
    ds_read_b128 v[64:67], v1 offset:28672
    ds_read_b128 v[68:71], v2 offset:28672
    ds_read_b128 v[72:75], v1 offset:30720
    s_waitcnt lgkmcnt(11)
    ds_read_b128 v[76:79], v2 offset:30720
    s_waitcnt vmcnt(8)
    ds_read_b128 v[80:83], v1 offset:32768
    ds_read_b128 v[84:87], v2 offset:32768
    ds_read_b128 v[88:91], v1 offset:34816
    s_waitcnt lgkmcnt(11)
    ds_read_b128 v[92:95], v2 offset:34816
    s_waitcnt lgkmcnt(0)
    v_lshl_add_u32 v16, v16, 8, v8
    v_lshl_add_u32 v17, v17, 8, v9
    v_lshl_add_u32 v18, v18, 8, v10
    v_lshl_add_u32 v19, v19, 8, v11
    s_add_u32 m0, s6, 28672
    s_nop 0
    buffer_load_dwordx4 v16, s[44:47], 0 offen offset:0  lds
    buffer_load_dwordx4 v17, s[44:47], 0 offen offset:1024  lds
    buffer_load_dwordx4 v18, s[44:47], 0 offen offset:2048  lds
    buffer_load_dwordx4 v19, s[44:47], 0 offen offset:3072  lds
    s_lshl_b32 s9, s66, 2
    v_add_u32 v30, s9, v7
    ds_read_b32 v16, v30 offset:0
    ds_read_b32 v17, v30 offset:832
    ds_read_b32 v18, v30 offset:1664
    ds_read_b32 v19, v30 offset:2496
    v_lshl_add_u32 v20, v20, 8, v8
    v_lshl_add_u32 v21, v21, 8, v9
    v_lshl_add_u32 v22, v22, 8, v10
    v_lshl_add_u32 v23, v23, 8, v11
    s_add_u32 m0, s6, 32768
    s_nop 0
    buffer_load_dwordx4 v20, s[44:47], 0 offen offset:0  lds
    buffer_load_dwordx4 v21, s[44:47], 0 offen offset:1024  lds
    buffer_load_dwordx4 v22, s[44:47], 0 offen offset:2048  lds
    buffer_load_dwordx4 v23, s[44:47], 0 offen offset:3072  lds
    s_lshl_b32 s9, s66, 2
    v_add_u32 v30, s9, v7
    ds_read_b32 v20, v30 offset:3328
    ds_read_b32 v21, v30 offset:4160
    ds_read_b32 v22, v30 offset:4992
    ds_read_b32 v23, v30 offset:5824
    s_add_u32 m0, s6, 16384
    s_lshl_b32 s8, s65, 17
    s_add_u32 s8, s8, s79
    buffer_load_dwordx4 v12, s[48:51], s8 offen offset:0 lds
    buffer_load_dwordx4 v13, s[48:51], s8 offen offset:1024 lds
    buffer_load_dwordx4 v14, s[48:51], s8 offen offset:2048 lds
    buffer_load_dwordx4 v15, s[48:51], s8 offen offset:3072 lds
    v_mfma_f32_16x16x32_bf16 v[192:195], v[32:35], v[64:67], 0
    ds_read_b64_tr_b16 v[48:49], v3 offset:4096
    ds_read_b64_tr_b16 v[50:51], v3 offset:4608
    v_mfma_f32_16x16x32_bf16 v[196:199], v[32:35], v[72:75], 0
    ds_read_b64_tr_b16 v[52:53], v4 offset:4096
    ds_read_b64_tr_b16 v[54:55], v4 offset:4608
    v_mfma_f32_16x16x32_bf16 v[200:203], v[32:35], v[80:83], 0
    ds_read_b64_tr_b16 v[56:57], v5 offset:4096
    ds_read_b64_tr_b16 v[58:59], v5 offset:4608
    v_mfma_f32_16x16x32_bf16 v[204:207], v[32:35], v[88:91], 0
    ds_read_b64_tr_b16 v[60:61], v6 offset:4096
    s_waitcnt lgkmcnt(11)
    ds_read_b64_tr_b16 v[62:63], v6 offset:4608
    v_mfma_f32_16x16x32_bf16 v[208:211], v[36:39], v[64:67], 0
    v_mfma_f32_16x16x32_bf16 v[212:215], v[36:39], v[72:75], 0
    v_mfma_f32_16x16x32_bf16 v[216:219], v[36:39], v[80:83], 0
    v_mfma_f32_16x16x32_bf16 v[220:223], v[36:39], v[88:91], 0
    v_mfma_f32_16x16x32_bf16 v[224:227], v[40:43], v[64:67], 0
    v_mfma_f32_16x16x32_bf16 v[228:231], v[40:43], v[72:75], 0
    v_mfma_f32_16x16x32_bf16 v[232:235], v[40:43], v[80:83], 0
    s_waitcnt lgkmcnt(0)
    s_add_u32 m0, s6, 20480
    v_mfma_f32_16x16x32_bf16 v[236:239], v[40:43], v[88:91], 0
    s_lshl_b32 s8, s65, 17
    s_add_u32 s8, s8, s79
    v_mfma_f32_16x16x32_bf16 v[240:243], v[44:47], v[64:67], 0
    s_add_u32 s8, s8, 32768
    buffer_load_dwordx4 v12, s[48:51], s8 offen offset:0 lds
    v_mfma_f32_16x16x32_bf16 v[244:247], v[44:47], v[72:75], 0
    buffer_load_dwordx4 v13, s[48:51], s8 offen offset:1024 lds
    buffer_load_dwordx4 v14, s[48:51], s8 offen offset:2048 lds
    v_mfma_f32_16x16x32_bf16 v[248:251], v[44:47], v[80:83], 0
    buffer_load_dwordx4 v15, s[48:51], s8 offen offset:3072 lds
    v_mfma_f32_16x16x32_bf16 v[252:255], v[44:47], v[88:91], 0
    v_mfma_f32_16x16x32_bf16 v[192:195], v[48:51], v[68:71], v[192:195]
    s_waitcnt vmcnt(20)
    ds_read_b64_tr_b16 v[32:33], v3 offset:8192
    ds_read_b64_tr_b16 v[34:35], v3 offset:8704
    v_mfma_f32_16x16x32_bf16 v[196:199], v[48:51], v[76:79], v[196:199]
    ds_read_b64_tr_b16 v[36:37], v4 offset:8192
    ds_read_b64_tr_b16 v[38:39], v4 offset:8704
    v_mfma_f32_16x16x32_bf16 v[200:203], v[48:51], v[84:87], v[200:203]
    ds_read_b64_tr_b16 v[40:41], v5 offset:8192
    ds_read_b64_tr_b16 v[42:43], v5 offset:8704
    v_mfma_f32_16x16x32_bf16 v[204:207], v[48:51], v[92:95], v[204:207]
    ds_read_b64_tr_b16 v[44:45], v6 offset:8192
    ds_read_b64_tr_b16 v[46:47], v6 offset:8704
    v_mfma_f32_16x16x32_bf16 v[208:211], v[52:55], v[68:71], v[208:211]
    v_mfma_f32_16x16x32_bf16 v[212:215], v[52:55], v[76:79], v[212:215]
    v_mfma_f32_16x16x32_bf16 v[216:219], v[52:55], v[84:87], v[216:219]
    v_mfma_f32_16x16x32_bf16 v[220:223], v[52:55], v[92:95], v[220:223]
    v_mfma_f32_16x16x32_bf16 v[224:227], v[56:59], v[68:71], v[224:227]
    v_mfma_f32_16x16x32_bf16 v[228:231], v[56:59], v[76:79], v[228:231]
    v_mfma_f32_16x16x32_bf16 v[232:235], v[56:59], v[84:87], v[232:235]
    s_waitcnt lgkmcnt(0)
    s_add_u32 m0, s6, 24576
    v_mfma_f32_16x16x32_bf16 v[236:239], v[56:59], v[92:95], v[236:239]
    s_lshl_b32 s8, s65, 17
    s_add_u32 s8, s8, s78
    v_mfma_f32_16x16x32_bf16 v[240:243], v[60:63], v[68:71], v[240:243]
    buffer_load_dwordx4 v12, s[48:51], s8 offen offset:0 lds
    buffer_load_dwordx4 v13, s[48:51], s8 offen offset:1024 lds
    v_mfma_f32_16x16x32_bf16 v[244:247], v[60:63], v[76:79], v[244:247]
    buffer_load_dwordx4 v14, s[48:51], s8 offen offset:2048 lds
    buffer_load_dwordx4 v15, s[48:51], s8 offen offset:3072 lds
    v_mfma_f32_16x16x32_bf16 v[248:251], v[60:63], v[84:87], v[248:251]
    v_mfma_f32_16x16x32_bf16 v[252:255], v[60:63], v[92:95], v[252:255]
    v_mfma_f32_16x16x32_bf16 v[128:131], v[32:35], v[64:67], 0
    s_waitcnt vmcnt(20)
    ds_read_b64_tr_b16 v[48:49], v3 offset:12288
    ds_read_b64_tr_b16 v[50:51], v3 offset:12800
    v_mfma_f32_16x16x32_bf16 v[132:135], v[32:35], v[72:75], 0
    ds_read_b64_tr_b16 v[52:53], v4 offset:12288
    ds_read_b64_tr_b16 v[54:55], v4 offset:12800
    v_mfma_f32_16x16x32_bf16 v[136:139], v[32:35], v[80:83], 0
    ds_read_b64_tr_b16 v[56:57], v5 offset:12288
    ds_read_b64_tr_b16 v[58:59], v5 offset:12800
    v_mfma_f32_16x16x32_bf16 v[140:143], v[32:35], v[88:91], 0
    ds_read_b64_tr_b16 v[60:61], v6 offset:12288
    ds_read_b64_tr_b16 v[62:63], v6 offset:12800
    v_mfma_f32_16x16x32_bf16 v[144:147], v[36:39], v[64:67], 0
    s_waitcnt vmcnt(16)
    ds_read_b128 v[96:99], v1 offset:28672
    ds_read_b128 v[100:103], v2 offset:28672
    v_mfma_f32_16x16x32_bf16 v[148:151], v[36:39], v[72:75], 0
    ds_read_b128 v[104:107], v1 offset:30720
    ds_read_b128 v[108:111], v2 offset:30720
    v_mfma_f32_16x16x32_bf16 v[152:155], v[36:39], v[80:83], 0
    v_mfma_f32_16x16x32_bf16 v[156:159], v[36:39], v[88:91], 0
    v_mfma_f32_16x16x32_bf16 v[160:163], v[40:43], v[64:67], 0
    v_mfma_f32_16x16x32_bf16 v[164:167], v[40:43], v[72:75], 0
    v_mfma_f32_16x16x32_bf16 v[168:171], v[40:43], v[80:83], 0
    s_waitcnt lgkmcnt(0)
    s_add_u32 m0, s6, 0
    s_lshl_b32 s8, s65, 17
    s_add_u32 s8, s8, s78
    s_add_u32 s8, s8, 32768
    buffer_load_dwordx4 v12, s[48:51], s8 offen offset:0 lds
    v_mfma_f32_16x16x32_bf16 v[172:175], v[40:43], v[88:91], 0
    buffer_load_dwordx4 v13, s[48:51], s8 offen offset:1024 lds
    buffer_load_dwordx4 v14, s[48:51], s8 offen offset:2048 lds
    buffer_load_dwordx4 v15, s[48:51], s8 offen offset:3072 lds
    v_lshl_add_u32 v16, v16, 8, v8
    v_lshl_add_u32 v17, v17, 8, v9
    v_mfma_f32_16x16x32_bf16 v[176:179], v[44:47], v[64:67], 0
    v_lshl_add_u32 v18, v18, 8, v10
    v_lshl_add_u32 v19, v19, 8, v11
    s_add_u32 m0, s6, 28672
    s_nop 0
    buffer_load_dwordx4 v16, s[44:47], 0 offen offset:0  lds
    buffer_load_dwordx4 v17, s[44:47], 0 offen offset:1024  lds
    v_mfma_f32_16x16x32_bf16 v[180:183], v[44:47], v[72:75], 0
    buffer_load_dwordx4 v18, s[44:47], 0 offen offset:2048  lds
    buffer_load_dwordx4 v19, s[44:47], 0 offen offset:3072  lds
    s_lshl_b32 s9, s67, 2
    v_add_u32 v30, s9, v7
    ds_read_b32 v16, v30 offset:0
    ds_read_b32 v17, v30 offset:832
    v_mfma_f32_16x16x32_bf16 v[184:187], v[44:47], v[80:83], 0
    ds_read_b32 v18, v30 offset:1664
    ds_read_b32 v19, v30 offset:2496
    v_mfma_f32_16x16x32_bf16 v[188:191], v[44:47], v[88:91], 0
    v_mfma_f32_16x16x32_bf16 v[128:131], v[48:51], v[68:71], v[128:131]
    s_waitcnt vmcnt(16)
    ds_read_b64_tr_b16 v[32:33], v3 offset:16384
    ds_read_b64_tr_b16 v[34:35], v3 offset:16896
    v_mfma_f32_16x16x32_bf16 v[132:135], v[48:51], v[76:79], v[132:135]
    ds_read_b64_tr_b16 v[36:37], v4 offset:16384
    ds_read_b64_tr_b16 v[38:39], v4 offset:16896
    v_mfma_f32_16x16x32_bf16 v[136:139], v[48:51], v[84:87], v[136:139]
    ds_read_b64_tr_b16 v[40:41], v5 offset:16384
    ds_read_b64_tr_b16 v[42:43], v5 offset:16896
    v_mfma_f32_16x16x32_bf16 v[140:143], v[48:51], v[92:95], v[140:143]
    ds_read_b64_tr_b16 v[44:45], v6 offset:16384
    ds_read_b64_tr_b16 v[46:47], v6 offset:16896
    v_mfma_f32_16x16x32_bf16 v[144:147], v[52:55], v[68:71], v[144:147]
    ds_read_b128 v[112:115], v1 offset:32768
    ds_read_b128 v[116:119], v2 offset:32768
    v_mfma_f32_16x16x32_bf16 v[148:151], v[52:55], v[76:79], v[148:151]
    ds_read_b128 v[120:123], v1 offset:34816
    s_waitcnt lgkmcnt(11)
    ds_read_b128 v[124:127], v2 offset:34816
    v_mfma_f32_16x16x32_bf16 v[152:155], v[52:55], v[84:87], v[152:155]
    v_mfma_f32_16x16x32_bf16 v[156:159], v[52:55], v[92:95], v[156:159]
    v_mfma_f32_16x16x32_bf16 v[160:163], v[56:59], v[68:71], v[160:163]
    v_mfma_f32_16x16x32_bf16 v[164:167], v[56:59], v[76:79], v[164:167]
    v_mfma_f32_16x16x32_bf16 v[168:171], v[56:59], v[84:87], v[168:171]
    s_waitcnt lgkmcnt(0)
    s_add_u32 m0, s6, 4096
    s_lshl_b32 s8, s66, 17
    s_add_u32 s8, s8, s79
    buffer_load_dwordx4 v12, s[48:51], s8 offen offset:0 lds
    v_mfma_f32_16x16x32_bf16 v[172:175], v[56:59], v[92:95], v[172:175]
    buffer_load_dwordx4 v13, s[48:51], s8 offen offset:1024 lds
    buffer_load_dwordx4 v14, s[48:51], s8 offen offset:2048 lds
    buffer_load_dwordx4 v15, s[48:51], s8 offen offset:3072 lds
    v_lshl_add_u32 v20, v20, 8, v8
    v_mfma_f32_16x16x32_bf16 v[176:179], v[60:63], v[68:71], v[176:179]
    v_lshl_add_u32 v21, v21, 8, v9
    v_lshl_add_u32 v22, v22, 8, v10
    v_lshl_add_u32 v23, v23, 8, v11
    s_add_u32 m0, s6, 32768
    s_nop 0
    v_mfma_f32_16x16x32_bf16 v[180:183], v[60:63], v[76:79], v[180:183]
    buffer_load_dwordx4 v20, s[44:47], 0 offen offset:0  lds
    buffer_load_dwordx4 v21, s[44:47], 0 offen offset:1024  lds
    buffer_load_dwordx4 v22, s[44:47], 0 offen offset:2048  lds
    buffer_load_dwordx4 v23, s[44:47], 0 offen offset:3072  lds
    s_lshl_b32 s9, s67, 2
    v_mfma_f32_16x16x32_bf16 v[184:187], v[60:63], v[84:87], v[184:187]
    v_add_u32 v30, s9, v7
    ds_read_b32 v20, v30 offset:3328
    ds_read_b32 v21, v30 offset:4160
    ds_read_b32 v22, v30 offset:4992
    ds_read_b32 v23, v30 offset:5824
    v_mfma_f32_16x16x32_bf16 v[188:191], v[60:63], v[92:95], v[188:191]
    s_cmp_lg_u32 s77, 1
    s_cbranch_scc1 L_nf1
    s_mov_b64 exec, 1
    buffer_store_byte v24, off, s[56:59], s13 sc1
    s_mov_b64 exec, -1
L_nf1:
    v_mfma_f32_16x16x32_bf16 v[192:195], v[32:35], v[96:99], v[192:195]
    s_waitcnt vmcnt(20)
    ds_read_b64_tr_b16 v[48:49], v3 offset:20480
    ds_read_b64_tr_b16 v[50:51], v3 offset:20992
    v_mfma_f32_16x16x32_bf16 v[196:199], v[32:35], v[104:107], v[196:199]
    ds_read_b64_tr_b16 v[52:53], v4 offset:20480
    ds_read_b64_tr_b16 v[54:55], v4 offset:20992
    v_mfma_f32_16x16x32_bf16 v[200:203], v[32:35], v[112:115], v[200:203]
    ds_read_b64_tr_b16 v[56:57], v5 offset:20480
    ds_read_b64_tr_b16 v[58:59], v5 offset:20992
    v_mfma_f32_16x16x32_bf16 v[204:207], v[32:35], v[120:123], v[204:207]
    ds_read_b64_tr_b16 v[60:61], v6 offset:20480
    ds_read_b64_tr_b16 v[62:63], v6 offset:20992
    v_mfma_f32_16x16x32_bf16 v[208:211], v[36:39], v[96:99], v[208:211]
    v_mfma_f32_16x16x32_bf16 v[212:215], v[36:39], v[104:107], v[212:215]
    v_mfma_f32_16x16x32_bf16 v[216:219], v[36:39], v[112:115], v[216:219]
    v_mfma_f32_16x16x32_bf16 v[220:223], v[36:39], v[120:123], v[220:223]
    v_mfma_f32_16x16x32_bf16 v[224:227], v[40:43], v[96:99], v[224:227]
    v_mfma_f32_16x16x32_bf16 v[228:231], v[40:43], v[104:107], v[228:231]
    v_mfma_f32_16x16x32_bf16 v[232:235], v[40:43], v[112:115], v[232:235]
    s_waitcnt lgkmcnt(0)
    s_add_u32 m0, s6, 8192
    v_mfma_f32_16x16x32_bf16 v[236:239], v[40:43], v[120:123], v[236:239]
    s_lshl_b32 s8, s66, 17
    s_add_u32 s8, s8, s79
    v_mfma_f32_16x16x32_bf16 v[240:243], v[44:47], v[96:99], v[240:243]
    s_add_u32 s8, s8, 32768
    buffer_load_dwordx4 v12, s[48:51], s8 offen offset:0 lds
    v_mfma_f32_16x16x32_bf16 v[244:247], v[44:47], v[104:107], v[244:247]
    buffer_load_dwordx4 v13, s[48:51], s8 offen offset:1024 lds
    buffer_load_dwordx4 v14, s[48:51], s8 offen offset:2048 lds
    v_mfma_f32_16x16x32_bf16 v[248:251], v[44:47], v[112:115], v[248:251]
    buffer_load_dwordx4 v15, s[48:51], s8 offen offset:3072 lds
    v_mfma_f32_16x16x32_bf16 v[252:255], v[44:47], v[120:123], v[252:255]
    v_mfma_f32_16x16x32_bf16 v[192:195], v[48:51], v[100:103], v[192:195]
    s_waitcnt vmcnt(20)
    ds_read_b64_tr_b16 v[32:33], v3 offset:24576
    ds_read_b64_tr_b16 v[34:35], v3 offset:25088
    v_mfma_f32_16x16x32_bf16 v[196:199], v[48:51], v[108:111], v[196:199]
    ds_read_b64_tr_b16 v[36:37], v4 offset:24576
    ds_read_b64_tr_b16 v[38:39], v4 offset:25088
    v_mfma_f32_16x16x32_bf16 v[200:203], v[48:51], v[116:119], v[200:203]
    ds_read_b64_tr_b16 v[40:41], v5 offset:24576
    ds_read_b64_tr_b16 v[42:43], v5 offset:25088
    v_mfma_f32_16x16x32_bf16 v[204:207], v[48:51], v[124:127], v[204:207]
    ds_read_b64_tr_b16 v[44:45], v6 offset:24576
    ds_read_b64_tr_b16 v[46:47], v6 offset:25088
    v_mfma_f32_16x16x32_bf16 v[208:211], v[52:55], v[100:103], v[208:211]
    v_mfma_f32_16x16x32_bf16 v[212:215], v[52:55], v[108:111], v[212:215]
    v_mfma_f32_16x16x32_bf16 v[216:219], v[52:55], v[116:119], v[216:219]
    v_mfma_f32_16x16x32_bf16 v[220:223], v[52:55], v[124:127], v[220:223]
    v_mfma_f32_16x16x32_bf16 v[224:227], v[56:59], v[100:103], v[224:227]
    v_mfma_f32_16x16x32_bf16 v[228:231], v[56:59], v[108:111], v[228:231]
    v_mfma_f32_16x16x32_bf16 v[232:235], v[56:59], v[116:119], v[232:235]
    s_waitcnt lgkmcnt(0)
    s_add_u32 m0, s6, 12288
    v_mfma_f32_16x16x32_bf16 v[236:239], v[56:59], v[124:127], v[236:239]
    s_lshl_b32 s8, s66, 17
    s_add_u32 s8, s8, s78
    v_mfma_f32_16x16x32_bf16 v[240:243], v[60:63], v[100:103], v[240:243]
    buffer_load_dwordx4 v12, s[48:51], s8 offen offset:0 lds
    buffer_load_dwordx4 v13, s[48:51], s8 offen offset:1024 lds
    v_mfma_f32_16x16x32_bf16 v[244:247], v[60:63], v[108:111], v[244:247]
    buffer_load_dwordx4 v14, s[48:51], s8 offen offset:2048 lds
    buffer_load_dwordx4 v15, s[48:51], s8 offen offset:3072 lds
    v_mfma_f32_16x16x32_bf16 v[248:251], v[60:63], v[116:119], v[248:251]
    v_mfma_f32_16x16x32_bf16 v[252:255], v[60:63], v[124:127], v[252:255]
    v_mfma_f32_16x16x32_bf16 v[128:131], v[32:35], v[96:99], v[128:131]
    s_waitcnt vmcnt(20)
    ds_read_b64_tr_b16 v[48:49], v3 offset:0
    ds_read_b64_tr_b16 v[50:51], v3 offset:512
    v_mfma_f32_16x16x32_bf16 v[132:135], v[32:35], v[104:107], v[132:135]
    ds_read_b64_tr_b16 v[52:53], v4 offset:0
    ds_read_b64_tr_b16 v[54:55], v4 offset:512
    v_mfma_f32_16x16x32_bf16 v[136:139], v[32:35], v[112:115], v[136:139]
    ds_read_b64_tr_b16 v[56:57], v5 offset:0
    ds_read_b64_tr_b16 v[58:59], v5 offset:512
    v_mfma_f32_16x16x32_bf16 v[140:143], v[32:35], v[120:123], v[140:143]
    ds_read_b64_tr_b16 v[60:61], v6 offset:0
    ds_read_b64_tr_b16 v[62:63], v6 offset:512
    v_mfma_f32_16x16x32_bf16 v[144:147], v[36:39], v[96:99], v[144:147]
    s_waitcnt vmcnt(16)
    ds_read_b128 v[64:67], v1 offset:28672
    ds_read_b128 v[68:71], v2 offset:28672
    v_mfma_f32_16x16x32_bf16 v[148:151], v[36:39], v[104:107], v[148:151]
    ds_read_b128 v[72:75], v1 offset:30720
    ds_read_b128 v[76:79], v2 offset:30720
    v_mfma_f32_16x16x32_bf16 v[152:155], v[36:39], v[112:115], v[152:155]
    v_mfma_f32_16x16x32_bf16 v[156:159], v[36:39], v[120:123], v[156:159]
    v_mfma_f32_16x16x32_bf16 v[160:163], v[40:43], v[96:99], v[160:163]
    v_mfma_f32_16x16x32_bf16 v[164:167], v[40:43], v[104:107], v[164:167]
    v_mfma_f32_16x16x32_bf16 v[168:171], v[40:43], v[112:115], v[168:171]
    s_waitcnt lgkmcnt(0)
    s_add_u32 m0, s6, 16384
    s_lshl_b32 s8, s66, 17
    s_add_u32 s8, s8, s78
    s_add_u32 s8, s8, 32768
    buffer_load_dwordx4 v12, s[48:51], s8 offen offset:0 lds
    v_mfma_f32_16x16x32_bf16 v[172:175], v[40:43], v[120:123], v[172:175]
    buffer_load_dwordx4 v13, s[48:51], s8 offen offset:1024 lds
    buffer_load_dwordx4 v14, s[48:51], s8 offen offset:2048 lds
    buffer_load_dwordx4 v15, s[48:51], s8 offen offset:3072 lds
    v_lshl_add_u32 v16, v16, 8, v8
    v_lshl_add_u32 v17, v17, 8, v9
    v_mfma_f32_16x16x32_bf16 v[176:179], v[44:47], v[96:99], v[176:179]
    v_lshl_add_u32 v18, v18, 8, v10
    v_lshl_add_u32 v19, v19, 8, v11
    s_add_u32 m0, s6, 28672
    s_nop 0
    buffer_load_dwordx4 v16, s[44:47], 0 offen offset:0  lds
    buffer_load_dwordx4 v17, s[44:47], 0 offen offset:1024  lds
    v_mfma_f32_16x16x32_bf16 v[180:183], v[44:47], v[104:107], v[180:183]
    buffer_load_dwordx4 v18, s[44:47], 0 offen offset:2048  lds
    buffer_load_dwordx4 v19, s[44:47], 0 offen offset:3072  lds
    s_lshl_b32 s9, s68, 2
    v_add_u32 v30, s9, v7
    ds_read_b32 v16, v30 offset:0
    ds_read_b32 v17, v30 offset:832
    v_mfma_f32_16x16x32_bf16 v[184:187], v[44:47], v[112:115], v[184:187]
    ds_read_b32 v18, v30 offset:1664
    ds_read_b32 v19, v30 offset:2496
    v_mfma_f32_16x16x32_bf16 v[188:191], v[44:47], v[120:123], v[188:191]
    v_mfma_f32_16x16x32_bf16 v[128:131], v[48:51], v[100:103], v[128:131]
    s_waitcnt vmcnt(20)
    ds_read_b64_tr_b16 v[32:33], v3 offset:4096
    ds_read_b64_tr_b16 v[34:35], v3 offset:4608
    v_mfma_f32_16x16x32_bf16 v[132:135], v[48:51], v[108:111], v[132:135]
    ds_read_b64_tr_b16 v[36:37], v4 offset:4096
    ds_read_b64_tr_b16 v[38:39], v4 offset:4608
    v_mfma_f32_16x16x32_bf16 v[136:139], v[48:51], v[116:119], v[136:139]
    ds_read_b64_tr_b16 v[40:41], v5 offset:4096
    ds_read_b64_tr_b16 v[42:43], v5 offset:4608
    v_mfma_f32_16x16x32_bf16 v[140:143], v[48:51], v[124:127], v[140:143]
    ds_read_b64_tr_b16 v[44:45], v6 offset:4096
    ds_read_b64_tr_b16 v[46:47], v6 offset:4608
    v_mfma_f32_16x16x32_bf16 v[144:147], v[52:55], v[100:103], v[144:147]
    s_waitcnt vmcnt(16)
    ds_read_b128 v[80:83], v1 offset:32768
    ds_read_b128 v[84:87], v2 offset:32768
    v_mfma_f32_16x16x32_bf16 v[148:151], v[52:55], v[108:111], v[148:151]
    ds_read_b128 v[88:91], v1 offset:34816
    s_waitcnt lgkmcnt(11)
    ds_read_b128 v[92:95], v2 offset:34816
    v_mfma_f32_16x16x32_bf16 v[152:155], v[52:55], v[116:119], v[152:155]
    v_mfma_f32_16x16x32_bf16 v[156:159], v[52:55], v[124:127], v[156:159]
    v_mfma_f32_16x16x32_bf16 v[160:163], v[56:59], v[100:103], v[160:163]
    v_mfma_f32_16x16x32_bf16 v[164:167], v[56:59], v[108:111], v[164:167]
    v_mfma_f32_16x16x32_bf16 v[168:171], v[56:59], v[116:119], v[168:171]
    s_waitcnt lgkmcnt(0)
    s_add_u32 m0, s6, 20480
    s_lshl_b32 s8, s67, 17
    s_add_u32 s8, s8, s79
    buffer_load_dwordx4 v12, s[48:51], s8 offen offset:0 lds
    v_mfma_f32_16x16x32_bf16 v[172:175], v[56:59], v[124:127], v[172:175]
    buffer_load_dwordx4 v13, s[48:51], s8 offen offset:1024 lds
    buffer_load_dwordx4 v14, s[48:51], s8 offen offset:2048 lds
    buffer_load_dwordx4 v15, s[48:51], s8 offen offset:3072 lds
    v_lshl_add_u32 v20, v20, 8, v8
    v_mfma_f32_16x16x32_bf16 v[176:179], v[60:63], v[100:103], v[176:179]
    v_lshl_add_u32 v21, v21, 8, v9
    v_lshl_add_u32 v22, v22, 8, v10
    v_lshl_add_u32 v23, v23, 8, v11
    s_add_u32 m0, s6, 32768
    s_nop 0
    v_mfma_f32_16x16x32_bf16 v[180:183], v[60:63], v[108:111], v[180:183]
    buffer_load_dwordx4 v20, s[44:47], 0 offen offset:0  lds
    buffer_load_dwordx4 v21, s[44:47], 0 offen offset:1024  lds
    buffer_load_dwordx4 v22, s[44:47], 0 offen offset:2048  lds
    buffer_load_dwordx4 v23, s[44:47], 0 offen offset:3072  lds
    s_lshl_b32 s9, s68, 2
    v_mfma_f32_16x16x32_bf16 v[184:187], v[60:63], v[116:119], v[184:187]
    v_add_u32 v30, s9, v7
    ds_read_b32 v20, v30 offset:3328
    ds_read_b32 v21, v30 offset:4160
    ds_read_b32 v22, v30 offset:4992
    ds_read_b32 v23, v30 offset:5824
    v_mfma_f32_16x16x32_bf16 v[188:191], v[60:63], v[124:127], v[188:191]
    s_cmp_lg_u32 s77, 2
    s_cbranch_scc1 L_nf2
    s_mov_b64 exec, 1
    buffer_store_byte v24, off, s[56:59], s13 sc1
    s_mov_b64 exec, -1
L_nf2:
    v_mfma_f32_16x16x32_bf16 v[192:195], v[32:35], v[64:67], v[192:195]
    s_waitcnt vmcnt(20)
    ds_read_b64_tr_b16 v[48:49], v3 offset:8192
    ds_read_b64_tr_b16 v[50:51], v3 offset:8704
    v_mfma_f32_16x16x32_bf16 v[196:199], v[32:35], v[72:75], v[196:199]
    ds_read_b64_tr_b16 v[52:53], v4 offset:8192
    ds_read_b64_tr_b16 v[54:55], v4 offset:8704
    v_mfma_f32_16x16x32_bf16 v[200:203], v[32:35], v[80:83], v[200:203]
    ds_read_b64_tr_b16 v[56:57], v5 offset:8192
    ds_read_b64_tr_b16 v[58:59], v5 offset:8704
    v_mfma_f32_16x16x32_bf16 v[204:207], v[32:35], v[88:91], v[204:207]
    ds_read_b64_tr_b16 v[60:61], v6 offset:8192
    ds_read_b64_tr_b16 v[62:63], v6 offset:8704
    v_mfma_f32_16x16x32_bf16 v[208:211], v[36:39], v[64:67], v[208:211]
    v_mfma_f32_16x16x32_bf16 v[212:215], v[36:39], v[72:75], v[212:215]
    v_mfma_f32_16x16x32_bf16 v[216:219], v[36:39], v[80:83], v[216:219]
    v_mfma_f32_16x16x32_bf16 v[220:223], v[36:39], v[88:91], v[220:223]
    v_mfma_f32_16x16x32_bf16 v[224:227], v[40:43], v[64:67], v[224:227]
    v_mfma_f32_16x16x32_bf16 v[228:231], v[40:43], v[72:75], v[228:231]
    v_mfma_f32_16x16x32_bf16 v[232:235], v[40:43], v[80:83], v[232:235]
    s_waitcnt lgkmcnt(0)
    s_add_u32 m0, s6, 24576
    v_mfma_f32_16x16x32_bf16 v[236:239], v[40:43], v[88:91], v[236:239]
    s_lshl_b32 s8, s67, 17
    s_add_u32 s8, s8, s79
    v_mfma_f32_16x16x32_bf16 v[240:243], v[44:47], v[64:67], v[240:243]
    s_add_u32 s8, s8, 32768
    buffer_load_dwordx4 v12, s[48:51], s8 offen offset:0 lds
    v_mfma_f32_16x16x32_bf16 v[244:247], v[44:47], v[72:75], v[244:247]
    buffer_load_dwordx4 v13, s[48:51], s8 offen offset:1024 lds
    buffer_load_dwordx4 v14, s[48:51], s8 offen offset:2048 lds
    v_mfma_f32_16x16x32_bf16 v[248:251], v[44:47], v[80:83], v[248:251]
    buffer_load_dwordx4 v15, s[48:51], s8 offen offset:3072 lds
    v_mfma_f32_16x16x32_bf16 v[252:255], v[44:47], v[88:91], v[252:255]
    v_mfma_f32_16x16x32_bf16 v[192:195], v[48:51], v[68:71], v[192:195]
    s_waitcnt vmcnt(20)
    ds_read_b64_tr_b16 v[32:33], v3 offset:12288
    ds_read_b64_tr_b16 v[34:35], v3 offset:12800
    v_mfma_f32_16x16x32_bf16 v[196:199], v[48:51], v[76:79], v[196:199]
    ds_read_b64_tr_b16 v[36:37], v4 offset:12288
    ds_read_b64_tr_b16 v[38:39], v4 offset:12800
    v_mfma_f32_16x16x32_bf16 v[200:203], v[48:51], v[84:87], v[200:203]
    ds_read_b64_tr_b16 v[40:41], v5 offset:12288
    ds_read_b64_tr_b16 v[42:43], v5 offset:12800
    v_mfma_f32_16x16x32_bf16 v[204:207], v[48:51], v[92:95], v[204:207]
    ds_read_b64_tr_b16 v[44:45], v6 offset:12288
    ds_read_b64_tr_b16 v[46:47], v6 offset:12800
    v_mfma_f32_16x16x32_bf16 v[208:211], v[52:55], v[68:71], v[208:211]
    v_mfma_f32_16x16x32_bf16 v[212:215], v[52:55], v[76:79], v[212:215]
    v_mfma_f32_16x16x32_bf16 v[216:219], v[52:55], v[84:87], v[216:219]
    v_mfma_f32_16x16x32_bf16 v[220:223], v[52:55], v[92:95], v[220:223]
    v_mfma_f32_16x16x32_bf16 v[224:227], v[56:59], v[68:71], v[224:227]
    v_mfma_f32_16x16x32_bf16 v[228:231], v[56:59], v[76:79], v[228:231]
    v_mfma_f32_16x16x32_bf16 v[232:235], v[56:59], v[84:87], v[232:235]
    s_waitcnt lgkmcnt(0)
    s_add_u32 m0, s6, 0
    v_mfma_f32_16x16x32_bf16 v[236:239], v[56:59], v[92:95], v[236:239]
    s_lshl_b32 s8, s67, 17
    s_add_u32 s8, s8, s78
    v_mfma_f32_16x16x32_bf16 v[240:243], v[60:63], v[68:71], v[240:243]
    buffer_load_dwordx4 v12, s[48:51], s8 offen offset:0 lds
    buffer_load_dwordx4 v13, s[48:51], s8 offen offset:1024 lds
    v_mfma_f32_16x16x32_bf16 v[244:247], v[60:63], v[76:79], v[244:247]
    buffer_load_dwordx4 v14, s[48:51], s8 offen offset:2048 lds
    buffer_load_dwordx4 v15, s[48:51], s8 offen offset:3072 lds
    v_mfma_f32_16x16x32_bf16 v[248:251], v[60:63], v[84:87], v[248:251]
    v_mfma_f32_16x16x32_bf16 v[252:255], v[60:63], v[92:95], v[252:255]
    v_mfma_f32_16x16x32_bf16 v[128:131], v[32:35], v[64:67], v[128:131]
    s_waitcnt vmcnt(20)
    ds_read_b64_tr_b16 v[48:49], v3 offset:16384
    ds_read_b64_tr_b16 v[50:51], v3 offset:16896
    v_mfma_f32_16x16x32_bf16 v[132:135], v[32:35], v[72:75], v[132:135]
    ds_read_b64_tr_b16 v[52:53], v4 offset:16384
    ds_read_b64_tr_b16 v[54:55], v4 offset:16896
    v_mfma_f32_16x16x32_bf16 v[136:139], v[32:35], v[80:83], v[136:139]
    ds_read_b64_tr_b16 v[56:57], v5 offset:16384
    ds_read_b64_tr_b16 v[58:59], v5 offset:16896
    v_mfma_f32_16x16x32_bf16 v[140:143], v[32:35], v[88:91], v[140:143]
    ds_read_b64_tr_b16 v[60:61], v6 offset:16384
    ds_read_b64_tr_b16 v[62:63], v6 offset:16896
    v_mfma_f32_16x16x32_bf16 v[144:147], v[36:39], v[64:67], v[144:147]
    s_waitcnt vmcnt(16)
    ds_read_b128 v[96:99], v1 offset:28672
    ds_read_b128 v[100:103], v2 offset:28672
    v_mfma_f32_16x16x32_bf16 v[148:151], v[36:39], v[72:75], v[148:151]
    ds_read_b128 v[104:107], v1 offset:30720
    ds_read_b128 v[108:111], v2 offset:30720
    v_mfma_f32_16x16x32_bf16 v[152:155], v[36:39], v[80:83], v[152:155]
    v_mfma_f32_16x16x32_bf16 v[156:159], v[36:39], v[88:91], v[156:159]
    v_mfma_f32_16x16x32_bf16 v[160:163], v[40:43], v[64:67], v[160:163]
    v_mfma_f32_16x16x32_bf16 v[164:167], v[40:43], v[72:75], v[164:167]
    v_mfma_f32_16x16x32_bf16 v[168:171], v[40:43], v[80:83], v[168:171]
    s_waitcnt lgkmcnt(0)
    s_add_u32 m0, s6, 4096
    s_lshl_b32 s8, s67, 17
    s_add_u32 s8, s8, s78
    s_add_u32 s8, s8, 32768
    buffer_load_dwordx4 v12, s[48:51], s8 offen offset:0 lds
    v_mfma_f32_16x16x32_bf16 v[172:175], v[40:43], v[88:91], v[172:175]
    buffer_load_dwordx4 v13, s[48:51], s8 offen offset:1024 lds
    buffer_load_dwordx4 v14, s[48:51], s8 offen offset:2048 lds
    buffer_load_dwordx4 v15, s[48:51], s8 offen offset:3072 lds
    v_lshl_add_u32 v16, v16, 8, v8
    v_lshl_add_u32 v17, v17, 8, v9
    v_mfma_f32_16x16x32_bf16 v[176:179], v[44:47], v[64:67], v[176:179]
    v_lshl_add_u32 v18, v18, 8, v10
    v_lshl_add_u32 v19, v19, 8, v11
    s_add_u32 m0, s6, 28672
    s_nop 0
    buffer_load_dwordx4 v16, s[44:47], 0 offen offset:0  lds
    buffer_load_dwordx4 v17, s[44:47], 0 offen offset:1024  lds
    v_mfma_f32_16x16x32_bf16 v[180:183], v[44:47], v[72:75], v[180:183]
    buffer_load_dwordx4 v18, s[44:47], 0 offen offset:2048  lds
    buffer_load_dwordx4 v19, s[44:47], 0 offen offset:3072  lds
    s_lshl_b32 s9, s69, 2
    v_add_u32 v30, s9, v7
    ds_read_b32 v16, v30 offset:0
    ds_read_b32 v17, v30 offset:832
    v_mfma_f32_16x16x32_bf16 v[184:187], v[44:47], v[80:83], v[184:187]
    ds_read_b32 v18, v30 offset:1664
    ds_read_b32 v19, v30 offset:2496
    v_mfma_f32_16x16x32_bf16 v[188:191], v[44:47], v[88:91], v[188:191]
    v_mfma_f32_16x16x32_bf16 v[128:131], v[48:51], v[68:71], v[128:131]
    s_waitcnt vmcnt(20)
    ds_read_b64_tr_b16 v[32:33], v3 offset:20480
    ds_read_b64_tr_b16 v[34:35], v3 offset:20992
    v_mfma_f32_16x16x32_bf16 v[132:135], v[48:51], v[76:79], v[132:135]
    ds_read_b64_tr_b16 v[36:37], v4 offset:20480
    ds_read_b64_tr_b16 v[38:39], v4 offset:20992
    v_mfma_f32_16x16x32_bf16 v[136:139], v[48:51], v[84:87], v[136:139]
    ds_read_b64_tr_b16 v[40:41], v5 offset:20480
    ds_read_b64_tr_b16 v[42:43], v5 offset:20992
    v_mfma_f32_16x16x32_bf16 v[140:143], v[48:51], v[92:95], v[140:143]
    ds_read_b64_tr_b16 v[44:45], v6 offset:20480
    ds_read_b64_tr_b16 v[46:47], v6 offset:20992
    v_mfma_f32_16x16x32_bf16 v[144:147], v[52:55], v[68:71], v[144:147]
    s_waitcnt vmcnt(16)
    ds_read_b128 v[112:115], v1 offset:32768
    ds_read_b128 v[116:119], v2 offset:32768
    v_mfma_f32_16x16x32_bf16 v[148:151], v[52:55], v[76:79], v[148:151]
    ds_read_b128 v[120:123], v1 offset:34816
    s_waitcnt lgkmcnt(11)
    ds_read_b128 v[124:127], v2 offset:34816
    v_mfma_f32_16x16x32_bf16 v[152:155], v[52:55], v[84:87], v[152:155]
    v_mfma_f32_16x16x32_bf16 v[156:159], v[52:55], v[92:95], v[156:159]
    v_mfma_f32_16x16x32_bf16 v[160:163], v[56:59], v[68:71], v[160:163]
    v_mfma_f32_16x16x32_bf16 v[164:167], v[56:59], v[76:79], v[164:167]
    v_mfma_f32_16x16x32_bf16 v[168:171], v[56:59], v[84:87], v[168:171]
    s_waitcnt lgkmcnt(0)
    s_add_u32 m0, s6, 8192
    s_lshl_b32 s8, s68, 17
    s_add_u32 s8, s8, s79
    buffer_load_dwordx4 v12, s[48:51], s8 offen offset:0 lds
    v_mfma_f32_16x16x32_bf16 v[172:175], v[56:59], v[92:95], v[172:175]
    buffer_load_dwordx4 v13, s[48:51], s8 offen offset:1024 lds
    buffer_load_dwordx4 v14, s[48:51], s8 offen offset:2048 lds
    buffer_load_dwordx4 v15, s[48:51], s8 offen offset:3072 lds
    v_lshl_add_u32 v20, v20, 8, v8
    v_mfma_f32_16x16x32_bf16 v[176:179], v[60:63], v[68:71], v[176:179]
    v_lshl_add_u32 v21, v21, 8, v9
    v_lshl_add_u32 v22, v22, 8, v10
    v_lshl_add_u32 v23, v23, 8, v11
    s_add_u32 m0, s6, 32768
    s_nop 0
    v_mfma_f32_16x16x32_bf16 v[180:183], v[60:63], v[76:79], v[180:183]
    buffer_load_dwordx4 v20, s[44:47], 0 offen offset:0  lds
    buffer_load_dwordx4 v21, s[44:47], 0 offen offset:1024  lds
    buffer_load_dwordx4 v22, s[44:47], 0 offen offset:2048  lds
    buffer_load_dwordx4 v23, s[44:47], 0 offen offset:3072  lds
    s_lshl_b32 s9, s69, 2
    v_mfma_f32_16x16x32_bf16 v[184:187], v[60:63], v[84:87], v[184:187]
    v_add_u32 v30, s9, v7
    ds_read_b32 v20, v30 offset:3328
    ds_read_b32 v21, v30 offset:4160
    ds_read_b32 v22, v30 offset:4992
    ds_read_b32 v23, v30 offset:5824
    v_mfma_f32_16x16x32_bf16 v[188:191], v[60:63], v[92:95], v[188:191]
    s_cmp_lg_u32 s77, 3
    s_cbranch_scc1 L_nf3
    s_mov_b64 exec, 1
    buffer_store_byte v24, off, s[56:59], s13 sc1
    s_mov_b64 exec, -1
L_nf3:
    v_mfma_f32_16x16x32_bf16 v[192:195], v[32:35], v[96:99], v[192:195]
    s_waitcnt vmcnt(20)
    ds_read_b64_tr_b16 v[48:49], v3 offset:24576
    ds_read_b64_tr_b16 v[50:51], v3 offset:25088
    v_mfma_f32_16x16x32_bf16 v[196:199], v[32:35], v[104:107], v[196:199]
    ds_read_b64_tr_b16 v[52:53], v4 offset:24576
    ds_read_b64_tr_b16 v[54:55], v4 offset:25088
    v_mfma_f32_16x16x32_bf16 v[200:203], v[32:35], v[112:115], v[200:203]
    ds_read_b64_tr_b16 v[56:57], v5 offset:24576
    ds_read_b64_tr_b16 v[58:59], v5 offset:25088
    v_mfma_f32_16x16x32_bf16 v[204:207], v[32:35], v[120:123], v[204:207]
    ds_read_b64_tr_b16 v[60:61], v6 offset:24576
    ds_read_b64_tr_b16 v[62:63], v6 offset:25088
    v_mfma_f32_16x16x32_bf16 v[208:211], v[36:39], v[96:99], v[208:211]
    v_mfma_f32_16x16x32_bf16 v[212:215], v[36:39], v[104:107], v[212:215]
    v_mfma_f32_16x16x32_bf16 v[216:219], v[36:39], v[112:115], v[216:219]
    v_mfma_f32_16x16x32_bf16 v[220:223], v[36:39], v[120:123], v[220:223]
    v_mfma_f32_16x16x32_bf16 v[224:227], v[40:43], v[96:99], v[224:227]
    v_mfma_f32_16x16x32_bf16 v[228:231], v[40:43], v[104:107], v[228:231]
    v_mfma_f32_16x16x32_bf16 v[232:235], v[40:43], v[112:115], v[232:235]
    s_waitcnt lgkmcnt(0)
    s_add_u32 m0, s6, 12288
    v_mfma_f32_16x16x32_bf16 v[236:239], v[40:43], v[120:123], v[236:239]
    s_lshl_b32 s8, s68, 17
    s_add_u32 s8, s8, s79
    v_mfma_f32_16x16x32_bf16 v[240:243], v[44:47], v[96:99], v[240:243]
    s_add_u32 s8, s8, 32768
    buffer_load_dwordx4 v12, s[48:51], s8 offen offset:0 lds
    v_mfma_f32_16x16x32_bf16 v[244:247], v[44:47], v[104:107], v[244:247]
    buffer_load_dwordx4 v13, s[48:51], s8 offen offset:1024 lds
    buffer_load_dwordx4 v14, s[48:51], s8 offen offset:2048 lds
    v_mfma_f32_16x16x32_bf16 v[248:251], v[44:47], v[112:115], v[248:251]
    buffer_load_dwordx4 v15, s[48:51], s8 offen offset:3072 lds
    v_mfma_f32_16x16x32_bf16 v[252:255], v[44:47], v[120:123], v[252:255]
    v_mfma_f32_16x16x32_bf16 v[192:195], v[48:51], v[100:103], v[192:195]
    s_waitcnt vmcnt(20)
    ds_read_b64_tr_b16 v[32:33], v3 offset:0
    ds_read_b64_tr_b16 v[34:35], v3 offset:512
    v_mfma_f32_16x16x32_bf16 v[196:199], v[48:51], v[108:111], v[196:199]
    ds_read_b64_tr_b16 v[36:37], v4 offset:0
    ds_read_b64_tr_b16 v[38:39], v4 offset:512
    v_mfma_f32_16x16x32_bf16 v[200:203], v[48:51], v[116:119], v[200:203]
    ds_read_b64_tr_b16 v[40:41], v5 offset:0
    ds_read_b64_tr_b16 v[42:43], v5 offset:512
    v_mfma_f32_16x16x32_bf16 v[204:207], v[48:51], v[124:127], v[204:207]
    ds_read_b64_tr_b16 v[44:45], v6 offset:0
    ds_read_b64_tr_b16 v[46:47], v6 offset:512
    v_mfma_f32_16x16x32_bf16 v[208:211], v[52:55], v[100:103], v[208:211]
    v_mfma_f32_16x16x32_bf16 v[212:215], v[52:55], v[108:111], v[212:215]
    v_mfma_f32_16x16x32_bf16 v[216:219], v[52:55], v[116:119], v[216:219]
    v_mfma_f32_16x16x32_bf16 v[220:223], v[52:55], v[124:127], v[220:223]
    v_mfma_f32_16x16x32_bf16 v[224:227], v[56:59], v[100:103], v[224:227]
    v_mfma_f32_16x16x32_bf16 v[228:231], v[56:59], v[108:111], v[228:231]
    v_mfma_f32_16x16x32_bf16 v[232:235], v[56:59], v[116:119], v[232:235]
    s_waitcnt lgkmcnt(0)
    s_add_u32 m0, s6, 16384
    v_mfma_f32_16x16x32_bf16 v[236:239], v[56:59], v[124:127], v[236:239]
    s_lshl_b32 s8, s68, 17
    s_add_u32 s8, s8, s78
    v_mfma_f32_16x16x32_bf16 v[240:243], v[60:63], v[100:103], v[240:243]
    buffer_load_dwordx4 v12, s[48:51], s8 offen offset:0 lds
    buffer_load_dwordx4 v13, s[48:51], s8 offen offset:1024 lds
    v_mfma_f32_16x16x32_bf16 v[244:247], v[60:63], v[108:111], v[244:247]
    buffer_load_dwordx4 v14, s[48:51], s8 offen offset:2048 lds
    buffer_load_dwordx4 v15, s[48:51], s8 offen offset:3072 lds
    v_mfma_f32_16x16x32_bf16 v[248:251], v[60:63], v[116:119], v[248:251]
    v_mfma_f32_16x16x32_bf16 v[252:255], v[60:63], v[124:127], v[252:255]
    v_mfma_f32_16x16x32_bf16 v[128:131], v[32:35], v[96:99], v[128:131]
    s_waitcnt vmcnt(20)
    ds_read_b64_tr_b16 v[48:49], v3 offset:4096
    ds_read_b64_tr_b16 v[50:51], v3 offset:4608
    v_mfma_f32_16x16x32_bf16 v[132:135], v[32:35], v[104:107], v[132:135]
    ds_read_b64_tr_b16 v[52:53], v4 offset:4096
    ds_read_b64_tr_b16 v[54:55], v4 offset:4608
    v_mfma_f32_16x16x32_bf16 v[136:139], v[32:35], v[112:115], v[136:139]
    ds_read_b64_tr_b16 v[56:57], v5 offset:4096
    ds_read_b64_tr_b16 v[58:59], v5 offset:4608
    v_mfma_f32_16x16x32_bf16 v[140:143], v[32:35], v[120:123], v[140:143]
    ds_read_b64_tr_b16 v[60:61], v6 offset:4096
    ds_read_b64_tr_b16 v[62:63], v6 offset:4608
    v_mfma_f32_16x16x32_bf16 v[144:147], v[36:39], v[96:99], v[144:147]
    s_waitcnt vmcnt(16)
    ds_read_b128 v[64:67], v1 offset:28672
    ds_read_b128 v[68:71], v2 offset:28672
    v_mfma_f32_16x16x32_bf16 v[148:151], v[36:39], v[104:107], v[148:151]
    ds_read_b128 v[72:75], v1 offset:30720
    ds_read_b128 v[76:79], v2 offset:30720
    v_mfma_f32_16x16x32_bf16 v[152:155], v[36:39], v[112:115], v[152:155]
    v_mfma_f32_16x16x32_bf16 v[156:159], v[36:39], v[120:123], v[156:159]
    v_mfma_f32_16x16x32_bf16 v[160:163], v[40:43], v[96:99], v[160:163]
    v_mfma_f32_16x16x32_bf16 v[164:167], v[40:43], v[104:107], v[164:167]
    v_mfma_f32_16x16x32_bf16 v[168:171], v[40:43], v[112:115], v[168:171]
    s_waitcnt lgkmcnt(0)
    s_add_u32 m0, s6, 20480
    s_lshl_b32 s8, s68, 17
    s_add_u32 s8, s8, s78
    s_add_u32 s8, s8, 32768
    buffer_load_dwordx4 v12, s[48:51], s8 offen offset:0 lds
    v_mfma_f32_16x16x32_bf16 v[172:175], v[40:43], v[120:123], v[172:175]
    buffer_load_dwordx4 v13, s[48:51], s8 offen offset:1024 lds
    buffer_load_dwordx4 v14, s[48:51], s8 offen offset:2048 lds
    buffer_load_dwordx4 v15, s[48:51], s8 offen offset:3072 lds
    v_lshl_add_u32 v16, v16, 8, v8
    v_lshl_add_u32 v17, v17, 8, v9
    v_mfma_f32_16x16x32_bf16 v[176:179], v[44:47], v[96:99], v[176:179]
    v_lshl_add_u32 v18, v18, 8, v10
    v_lshl_add_u32 v19, v19, 8, v11
    s_add_u32 m0, s6, 28672
    s_nop 0
    buffer_load_dwordx4 v16, s[44:47], 0 offen offset:0  lds
    buffer_load_dwordx4 v17, s[44:47], 0 offen offset:1024  lds
    v_mfma_f32_16x16x32_bf16 v[180:183], v[44:47], v[104:107], v[180:183]
    buffer_load_dwordx4 v18, s[44:47], 0 offen offset:2048  lds
    buffer_load_dwordx4 v19, s[44:47], 0 offen offset:3072  lds
    s_lshl_b32 s9, s70, 2
    v_add_u32 v30, s9, v7
    ds_read_b32 v16, v30 offset:0
    ds_read_b32 v17, v30 offset:832
    v_mfma_f32_16x16x32_bf16 v[184:187], v[44:47], v[112:115], v[184:187]
    ds_read_b32 v18, v30 offset:1664
    ds_read_b32 v19, v30 offset:2496
    v_mfma_f32_16x16x32_bf16 v[188:191], v[44:47], v[120:123], v[188:191]
    v_mfma_f32_16x16x32_bf16 v[128:131], v[48:51], v[100:103], v[128:131]
    s_waitcnt vmcnt(20)
    ds_read_b64_tr_b16 v[32:33], v3 offset:8192
    ds_read_b64_tr_b16 v[34:35], v3 offset:8704
    v_mfma_f32_16x16x32_bf16 v[132:135], v[48:51], v[108:111], v[132:135]
    ds_read_b64_tr_b16 v[36:37], v4 offset:8192
    ds_read_b64_tr_b16 v[38:39], v4 offset:8704
    v_mfma_f32_16x16x32_bf16 v[136:139], v[48:51], v[116:119], v[136:139]
    ds_read_b64_tr_b16 v[40:41], v5 offset:8192
    ds_read_b64_tr_b16 v[42:43], v5 offset:8704
    v_mfma_f32_16x16x32_bf16 v[140:143], v[48:51], v[124:127], v[140:143]
    ds_read_b64_tr_b16 v[44:45], v6 offset:8192
    ds_read_b64_tr_b16 v[46:47], v6 offset:8704
    v_mfma_f32_16x16x32_bf16 v[144:147], v[52:55], v[100:103], v[144:147]
    s_waitcnt vmcnt(16)
    ds_read_b128 v[80:83], v1 offset:32768
    ds_read_b128 v[84:87], v2 offset:32768
    v_mfma_f32_16x16x32_bf16 v[148:151], v[52:55], v[108:111], v[148:151]
    ds_read_b128 v[88:91], v1 offset:34816
    s_waitcnt lgkmcnt(11)
    ds_read_b128 v[92:95], v2 offset:34816
    v_mfma_f32_16x16x32_bf16 v[152:155], v[52:55], v[116:119], v[152:155]
    v_mfma_f32_16x16x32_bf16 v[156:159], v[52:55], v[124:127], v[156:159]
    v_mfma_f32_16x16x32_bf16 v[160:163], v[56:59], v[100:103], v[160:163]
    v_mfma_f32_16x16x32_bf16 v[164:167], v[56:59], v[108:111], v[164:167]
    v_mfma_f32_16x16x32_bf16 v[168:171], v[56:59], v[116:119], v[168:171]
    s_waitcnt lgkmcnt(0)
    s_add_u32 m0, s6, 24576
    s_lshl_b32 s8, s69, 17
    s_add_u32 s8, s8, s79
    buffer_load_dwordx4 v12, s[48:51], s8 offen offset:0 lds
    v_mfma_f32_16x16x32_bf16 v[172:175], v[56:59], v[124:127], v[172:175]
    buffer_load_dwordx4 v13, s[48:51], s8 offen offset:1024 lds
    buffer_load_dwordx4 v14, s[48:51], s8 offen offset:2048 lds
    buffer_load_dwordx4 v15, s[48:51], s8 offen offset:3072 lds
    v_lshl_add_u32 v20, v20, 8, v8
    v_mfma_f32_16x16x32_bf16 v[176:179], v[60:63], v[100:103], v[176:179]
    v_lshl_add_u32 v21, v21, 8, v9
    v_lshl_add_u32 v22, v22, 8, v10
    v_lshl_add_u32 v23, v23, 8, v11
    s_add_u32 m0, s6, 32768
    s_nop 0
    v_mfma_f32_16x16x32_bf16 v[180:183], v[60:63], v[108:111], v[180:183]
    buffer_load_dwordx4 v20, s[44:47], 0 offen offset:0  lds
    buffer_load_dwordx4 v21, s[44:47], 0 offen offset:1024  lds
    buffer_load_dwordx4 v22, s[44:47], 0 offen offset:2048  lds
    buffer_load_dwordx4 v23, s[44:47], 0 offen offset:3072  lds
    s_lshl_b32 s9, s70, 2
    v_mfma_f32_16x16x32_bf16 v[184:187], v[60:63], v[116:119], v[184:187]
    v_add_u32 v30, s9, v7
    ds_read_b32 v20, v30 offset:3328
    ds_read_b32 v21, v30 offset:4160
    ds_read_b32 v22, v30 offset:4992
    ds_read_b32 v23, v30 offset:5824
    v_mfma_f32_16x16x32_bf16 v[188:191], v[60:63], v[124:127], v[188:191]
    s_cmp_lg_u32 s77, 4
    s_cbranch_scc1 L_nf4
    s_mov_b64 exec, 1
    buffer_store_byte v24, off, s[56:59], s13 sc1
    s_mov_b64 exec, -1
L_nf4:
    v_mfma_f32_16x16x32_bf16 v[192:195], v[32:35], v[64:67], v[192:195]
    s_waitcnt vmcnt(20)
    ds_read_b64_tr_b16 v[48:49], v3 offset:12288
    ds_read_b64_tr_b16 v[50:51], v3 offset:12800
    v_mfma_f32_16x16x32_bf16 v[196:199], v[32:35], v[72:75], v[196:199]
    ds_read_b64_tr_b16 v[52:53], v4 offset:12288
    ds_read_b64_tr_b16 v[54:55], v4 offset:12800
    v_mfma_f32_16x16x32_bf16 v[200:203], v[32:35], v[80:83], v[200:203]
    ds_read_b64_tr_b16 v[56:57], v5 offset:12288
    ds_read_b64_tr_b16 v[58:59], v5 offset:12800
    v_mfma_f32_16x16x32_bf16 v[204:207], v[32:35], v[88:91], v[204:207]
    ds_read_b64_tr_b16 v[60:61], v6 offset:12288
    ds_read_b64_tr_b16 v[62:63], v6 offset:12800
    v_mfma_f32_16x16x32_bf16 v[208:211], v[36:39], v[64:67], v[208:211]
    v_mfma_f32_16x16x32_bf16 v[212:215], v[36:39], v[72:75], v[212:215]
    v_mfma_f32_16x16x32_bf16 v[216:219], v[36:39], v[80:83], v[216:219]
    v_mfma_f32_16x16x32_bf16 v[220:223], v[36:39], v[88:91], v[220:223]
    v_mfma_f32_16x16x32_bf16 v[224:227], v[40:43], v[64:67], v[224:227]
    v_mfma_f32_16x16x32_bf16 v[228:231], v[40:43], v[72:75], v[228:231]
    v_mfma_f32_16x16x32_bf16 v[232:235], v[40:43], v[80:83], v[232:235]
    s_waitcnt lgkmcnt(0)
    s_add_u32 m0, s6, 0
    v_mfma_f32_16x16x32_bf16 v[236:239], v[40:43], v[88:91], v[236:239]
    s_lshl_b32 s8, s69, 17
    s_add_u32 s8, s8, s79
    v_mfma_f32_16x16x32_bf16 v[240:243], v[44:47], v[64:67], v[240:243]
    s_add_u32 s8, s8, 32768
    buffer_load_dwordx4 v12, s[48:51], s8 offen offset:0 lds
    v_mfma_f32_16x16x32_bf16 v[244:247], v[44:47], v[72:75], v[244:247]
    buffer_load_dwordx4 v13, s[48:51], s8 offen offset:1024 lds
    buffer_load_dwordx4 v14, s[48:51], s8 offen offset:2048 lds
    v_mfma_f32_16x16x32_bf16 v[248:251], v[44:47], v[80:83], v[248:251]
    buffer_load_dwordx4 v15, s[48:51], s8 offen offset:3072 lds
    v_mfma_f32_16x16x32_bf16 v[252:255], v[44:47], v[88:91], v[252:255]
    v_mfma_f32_16x16x32_bf16 v[192:195], v[48:51], v[68:71], v[192:195]
    s_waitcnt vmcnt(20)
    ds_read_b64_tr_b16 v[32:33], v3 offset:16384
    ds_read_b64_tr_b16 v[34:35], v3 offset:16896
    v_mfma_f32_16x16x32_bf16 v[196:199], v[48:51], v[76:79], v[196:199]
    ds_read_b64_tr_b16 v[36:37], v4 offset:16384
    ds_read_b64_tr_b16 v[38:39], v4 offset:16896
    v_mfma_f32_16x16x32_bf16 v[200:203], v[48:51], v[84:87], v[200:203]
    ds_read_b64_tr_b16 v[40:41], v5 offset:16384
    ds_read_b64_tr_b16 v[42:43], v5 offset:16896
    v_mfma_f32_16x16x32_bf16 v[204:207], v[48:51], v[92:95], v[204:207]
    ds_read_b64_tr_b16 v[44:45], v6 offset:16384
    ds_read_b64_tr_b16 v[46:47], v6 offset:16896
    v_mfma_f32_16x16x32_bf16 v[208:211], v[52:55], v[68:71], v[208:211]
    v_mfma_f32_16x16x32_bf16 v[212:215], v[52:55], v[76:79], v[212:215]
    v_mfma_f32_16x16x32_bf16 v[216:219], v[52:55], v[84:87], v[216:219]
    v_mfma_f32_16x16x32_bf16 v[220:223], v[52:55], v[92:95], v[220:223]
    v_mfma_f32_16x16x32_bf16 v[224:227], v[56:59], v[68:71], v[224:227]
    v_mfma_f32_16x16x32_bf16 v[228:231], v[56:59], v[76:79], v[228:231]
    v_mfma_f32_16x16x32_bf16 v[232:235], v[56:59], v[84:87], v[232:235]
    s_waitcnt lgkmcnt(0)
    s_add_u32 m0, s6, 4096
    v_mfma_f32_16x16x32_bf16 v[236:239], v[56:59], v[92:95], v[236:239]
    s_lshl_b32 s8, s69, 17
    s_add_u32 s8, s8, s78
    v_mfma_f32_16x16x32_bf16 v[240:243], v[60:63], v[68:71], v[240:243]
    buffer_load_dwordx4 v12, s[48:51], s8 offen offset:0 lds
    buffer_load_dwordx4 v13, s[48:51], s8 offen offset:1024 lds
    v_mfma_f32_16x16x32_bf16 v[244:247], v[60:63], v[76:79], v[244:247]
    buffer_load_dwordx4 v14, s[48:51], s8 offen offset:2048 lds
    buffer_load_dwordx4 v15, s[48:51], s8 offen offset:3072 lds
    v_mfma_f32_16x16x32_bf16 v[248:251], v[60:63], v[84:87], v[248:251]
    v_mfma_f32_16x16x32_bf16 v[252:255], v[60:63], v[92:95], v[252:255]
    v_mfma_f32_16x16x32_bf16 v[128:131], v[32:35], v[64:67], v[128:131]
    s_waitcnt vmcnt(20)
    ds_read_b64_tr_b16 v[48:49], v3 offset:20480
    ds_read_b64_tr_b16 v[50:51], v3 offset:20992
    v_mfma_f32_16x16x32_bf16 v[132:135], v[32:35], v[72:75], v[132:135]
    ds_read_b64_tr_b16 v[52:53], v4 offset:20480
    ds_read_b64_tr_b16 v[54:55], v4 offset:20992
    v_mfma_f32_16x16x32_bf16 v[136:139], v[32:35], v[80:83], v[136:139]
    ds_read_b64_tr_b16 v[56:57], v5 offset:20480
    ds_read_b64_tr_b16 v[58:59], v5 offset:20992
    v_mfma_f32_16x16x32_bf16 v[140:143], v[32:35], v[88:91], v[140:143]
    ds_read_b64_tr_b16 v[60:61], v6 offset:20480
    ds_read_b64_tr_b16 v[62:63], v6 offset:20992
    v_mfma_f32_16x16x32_bf16 v[144:147], v[36:39], v[64:67], v[144:147]
    s_waitcnt vmcnt(16)
    ds_read_b128 v[96:99], v1 offset:28672
    ds_read_b128 v[100:103], v2 offset:28672
    v_mfma_f32_16x16x32_bf16 v[148:151], v[36:39], v[72:75], v[148:151]
    ds_read_b128 v[104:107], v1 offset:30720
    ds_read_b128 v[108:111], v2 offset:30720
    v_mfma_f32_16x16x32_bf16 v[152:155], v[36:39], v[80:83], v[152:155]
    v_mfma_f32_16x16x32_bf16 v[156:159], v[36:39], v[88:91], v[156:159]
    v_mfma_f32_16x16x32_bf16 v[160:163], v[40:43], v[64:67], v[160:163]
    v_mfma_f32_16x16x32_bf16 v[164:167], v[40:43], v[72:75], v[164:167]
    v_mfma_f32_16x16x32_bf16 v[168:171], v[40:43], v[80:83], v[168:171]
    s_waitcnt lgkmcnt(0)
    s_add_u32 m0, s6, 8192
    s_lshl_b32 s8, s69, 17
    s_add_u32 s8, s8, s78
    s_add_u32 s8, s8, 32768
    buffer_load_dwordx4 v12, s[48:51], s8 offen offset:0 lds
    v_mfma_f32_16x16x32_bf16 v[172:175], v[40:43], v[88:91], v[172:175]
    buffer_load_dwordx4 v13, s[48:51], s8 offen offset:1024 lds
    buffer_load_dwordx4 v14, s[48:51], s8 offen offset:2048 lds
    buffer_load_dwordx4 v15, s[48:51], s8 offen offset:3072 lds
    v_lshl_add_u32 v16, v16, 8, v8
    v_lshl_add_u32 v17, v17, 8, v9
    v_mfma_f32_16x16x32_bf16 v[176:179], v[44:47], v[64:67], v[176:179]
    v_lshl_add_u32 v18, v18, 8, v10
    v_lshl_add_u32 v19, v19, 8, v11
    s_add_u32 m0, s6, 28672
    s_nop 0
    buffer_load_dwordx4 v16, s[44:47], 0 offen offset:0  lds
    buffer_load_dwordx4 v17, s[44:47], 0 offen offset:1024  lds
    v_mfma_f32_16x16x32_bf16 v[180:183], v[44:47], v[72:75], v[180:183]
    buffer_load_dwordx4 v18, s[44:47], 0 offen offset:2048  lds
    buffer_load_dwordx4 v19, s[44:47], 0 offen offset:3072  lds
    s_lshl_b32 s9, s71, 2
    v_add_u32 v30, s9, v7
    ds_read_b32 v16, v30 offset:0
    ds_read_b32 v17, v30 offset:832
    v_mfma_f32_16x16x32_bf16 v[184:187], v[44:47], v[80:83], v[184:187]
    ds_read_b32 v18, v30 offset:1664
    ds_read_b32 v19, v30 offset:2496
    v_mfma_f32_16x16x32_bf16 v[188:191], v[44:47], v[88:91], v[188:191]
    v_mfma_f32_16x16x32_bf16 v[128:131], v[48:51], v[68:71], v[128:131]
    s_waitcnt vmcnt(20)
    ds_read_b64_tr_b16 v[32:33], v3 offset:24576
    ds_read_b64_tr_b16 v[34:35], v3 offset:25088
    v_mfma_f32_16x16x32_bf16 v[132:135], v[48:51], v[76:79], v[132:135]
    ds_read_b64_tr_b16 v[36:37], v4 offset:24576
    ds_read_b64_tr_b16 v[38:39], v4 offset:25088
    v_mfma_f32_16x16x32_bf16 v[136:139], v[48:51], v[84:87], v[136:139]
    ds_read_b64_tr_b16 v[40:41], v5 offset:24576
    ds_read_b64_tr_b16 v[42:43], v5 offset:25088
    v_mfma_f32_16x16x32_bf16 v[140:143], v[48:51], v[92:95], v[140:143]
    ds_read_b64_tr_b16 v[44:45], v6 offset:24576
    ds_read_b64_tr_b16 v[46:47], v6 offset:25088
    v_mfma_f32_16x16x32_bf16 v[144:147], v[52:55], v[68:71], v[144:147]
    s_waitcnt vmcnt(16)
    ds_read_b128 v[112:115], v1 offset:32768
    ds_read_b128 v[116:119], v2 offset:32768
    v_mfma_f32_16x16x32_bf16 v[148:151], v[52:55], v[76:79], v[148:151]
    ds_read_b128 v[120:123], v1 offset:34816
    s_waitcnt lgkmcnt(11)
    ds_read_b128 v[124:127], v2 offset:34816
    v_mfma_f32_16x16x32_bf16 v[152:155], v[52:55], v[84:87], v[152:155]
    v_mfma_f32_16x16x32_bf16 v[156:159], v[52:55], v[92:95], v[156:159]
    v_mfma_f32_16x16x32_bf16 v[160:163], v[56:59], v[68:71], v[160:163]
    v_mfma_f32_16x16x32_bf16 v[164:167], v[56:59], v[76:79], v[164:167]
    v_mfma_f32_16x16x32_bf16 v[168:171], v[56:59], v[84:87], v[168:171]
    s_waitcnt lgkmcnt(0)
    s_add_u32 m0, s6, 12288
    s_lshl_b32 s8, s70, 17
    s_add_u32 s8, s8, s79
    buffer_load_dwordx4 v12, s[48:51], s8 offen offset:0 lds
    v_mfma_f32_16x16x32_bf16 v[172:175], v[56:59], v[92:95], v[172:175]
    buffer_load_dwordx4 v13, s[48:51], s8 offen offset:1024 lds
    buffer_load_dwordx4 v14, s[48:51], s8 offen offset:2048 lds
    buffer_load_dwordx4 v15, s[48:51], s8 offen offset:3072 lds
    v_lshl_add_u32 v20, v20, 8, v8
    v_mfma_f32_16x16x32_bf16 v[176:179], v[60:63], v[68:71], v[176:179]
    v_lshl_add_u32 v21, v21, 8, v9
    v_lshl_add_u32 v22, v22, 8, v10
    v_lshl_add_u32 v23, v23, 8, v11
    s_add_u32 m0, s6, 32768
    s_nop 0
    v_mfma_f32_16x16x32_bf16 v[180:183], v[60:63], v[76:79], v[180:183]
    buffer_load_dwordx4 v20, s[44:47], 0 offen offset:0  lds
    buffer_load_dwordx4 v21, s[44:47], 0 offen offset:1024  lds
    buffer_load_dwordx4 v22, s[44:47], 0 offen offset:2048  lds
    buffer_load_dwordx4 v23, s[44:47], 0 offen offset:3072  lds
    s_lshl_b32 s9, s71, 2
    v_mfma_f32_16x16x32_bf16 v[184:187], v[60:63], v[84:87], v[184:187]
    v_add_u32 v30, s9, v7
    ds_read_b32 v20, v30 offset:3328
    ds_read_b32 v21, v30 offset:4160
    ds_read_b32 v22, v30 offset:4992
    ds_read_b32 v23, v30 offset:5824
    v_mfma_f32_16x16x32_bf16 v[188:191], v[60:63], v[92:95], v[188:191]
    s_cmp_lg_u32 s77, 5
    s_cbranch_scc1 L_nf5
    s_mov_b64 exec, 1
    buffer_store_byte v24, off, s[56:59], s13 sc1
    s_mov_b64 exec, -1
L_nf5:
    v_mfma_f32_16x16x32_bf16 v[192:195], v[32:35], v[96:99], v[192:195]
    s_waitcnt vmcnt(20)
    ds_read_b64_tr_b16 v[48:49], v3 offset:0
    ds_read_b64_tr_b16 v[50:51], v3 offset:512
    v_mfma_f32_16x16x32_bf16 v[196:199], v[32:35], v[104:107], v[196:199]
    ds_read_b64_tr_b16 v[52:53], v4 offset:0
    ds_read_b64_tr_b16 v[54:55], v4 offset:512
    v_mfma_f32_16x16x32_bf16 v[200:203], v[32:35], v[112:115], v[200:203]
    ds_read_b64_tr_b16 v[56:57], v5 offset:0
    ds_read_b64_tr_b16 v[58:59], v5 offset:512
    v_mfma_f32_16x16x32_bf16 v[204:207], v[32:35], v[120:123], v[204:207]
    ds_read_b64_tr_b16 v[60:61], v6 offset:0
    ds_read_b64_tr_b16 v[62:63], v6 offset:512
    v_mfma_f32_16x16x32_bf16 v[208:211], v[36:39], v[96:99], v[208:211]
    v_mfma_f32_16x16x32_bf16 v[212:215], v[36:39], v[104:107], v[212:215]
    v_mfma_f32_16x16x32_bf16 v[216:219], v[36:39], v[112:115], v[216:219]
    v_mfma_f32_16x16x32_bf16 v[220:223], v[36:39], v[120:123], v[220:223]
    v_mfma_f32_16x16x32_bf16 v[224:227], v[40:43], v[96:99], v[224:227]
    v_mfma_f32_16x16x32_bf16 v[228:231], v[40:43], v[104:107], v[228:231]
    v_mfma_f32_16x16x32_bf16 v[232:235], v[40:43], v[112:115], v[232:235]
    s_waitcnt lgkmcnt(0)
    s_add_u32 m0, s6, 16384
    v_mfma_f32_16x16x32_bf16 v[236:239], v[40:43], v[120:123], v[236:239]
    s_lshl_b32 s8, s70, 17
    s_add_u32 s8, s8, s79
    v_mfma_f32_16x16x32_bf16 v[240:243], v[44:47], v[96:99], v[240:243]
    s_add_u32 s8, s8, 32768
    buffer_load_dwordx4 v12, s[48:51], s8 offen offset:0 lds
    v_mfma_f32_16x16x32_bf16 v[244:247], v[44:47], v[104:107], v[244:247]
    buffer_load_dwordx4 v13, s[48:51], s8 offen offset:1024 lds
    buffer_load_dwordx4 v14, s[48:51], s8 offen offset:2048 lds
    v_mfma_f32_16x16x32_bf16 v[248:251], v[44:47], v[112:115], v[248:251]
    buffer_load_dwordx4 v15, s[48:51], s8 offen offset:3072 lds
    v_mfma_f32_16x16x32_bf16 v[252:255], v[44:47], v[120:123], v[252:255]
    v_mfma_f32_16x16x32_bf16 v[192:195], v[48:51], v[100:103], v[192:195]
    s_waitcnt vmcnt(20)
    ds_read_b64_tr_b16 v[32:33], v3 offset:4096
    ds_read_b64_tr_b16 v[34:35], v3 offset:4608
    v_mfma_f32_16x16x32_bf16 v[196:199], v[48:51], v[108:111], v[196:199]
    ds_read_b64_tr_b16 v[36:37], v4 offset:4096
    ds_read_b64_tr_b16 v[38:39], v4 offset:4608
    v_mfma_f32_16x16x32_bf16 v[200:203], v[48:51], v[116:119], v[200:203]
    ds_read_b64_tr_b16 v[40:41], v5 offset:4096
    ds_read_b64_tr_b16 v[42:43], v5 offset:4608
    v_mfma_f32_16x16x32_bf16 v[204:207], v[48:51], v[124:127], v[204:207]
    ds_read_b64_tr_b16 v[44:45], v6 offset:4096
    ds_read_b64_tr_b16 v[46:47], v6 offset:4608
    v_mfma_f32_16x16x32_bf16 v[208:211], v[52:55], v[100:103], v[208:211]
    v_mfma_f32_16x16x32_bf16 v[212:215], v[52:55], v[108:111], v[212:215]
    v_mfma_f32_16x16x32_bf16 v[216:219], v[52:55], v[116:119], v[216:219]
    v_mfma_f32_16x16x32_bf16 v[220:223], v[52:55], v[124:127], v[220:223]
    v_mfma_f32_16x16x32_bf16 v[224:227], v[56:59], v[100:103], v[224:227]
    v_mfma_f32_16x16x32_bf16 v[228:231], v[56:59], v[108:111], v[228:231]
    v_mfma_f32_16x16x32_bf16 v[232:235], v[56:59], v[116:119], v[232:235]
    v_mfma_f32_16x16x32_bf16 v[236:239], v[56:59], v[124:127], v[236:239]
    v_mfma_f32_16x16x32_bf16 v[240:243], v[60:63], v[100:103], v[240:243]
    v_mfma_f32_16x16x32_bf16 v[244:247], v[60:63], v[108:111], v[244:247]
    v_mfma_f32_16x16x32_bf16 v[248:251], v[60:63], v[116:119], v[248:251]
    v_mfma_f32_16x16x32_bf16 v[252:255], v[60:63], v[124:127], v[252:255]
    s_waitcnt lgkmcnt(6)
    v_mfma_f32_16x16x32_bf16 v[128:131], v[32:35], v[96:99], v[128:131]
    s_waitcnt vmcnt(16)
    ds_read_b64_tr_b16 v[48:49], v3 offset:8192
    ds_read_b64_tr_b16 v[50:51], v3 offset:8704
    v_mfma_f32_16x16x32_bf16 v[132:135], v[32:35], v[104:107], v[132:135]
    ds_read_b64_tr_b16 v[52:53], v4 offset:8192
    ds_read_b64_tr_b16 v[54:55], v4 offset:8704
    v_mfma_f32_16x16x32_bf16 v[136:139], v[32:35], v[112:115], v[136:139]
    ds_read_b64_tr_b16 v[56:57], v5 offset:8192
    ds_read_b64_tr_b16 v[58:59], v5 offset:8704
    v_mfma_f32_16x16x32_bf16 v[140:143], v[32:35], v[120:123], v[140:143]
    ds_read_b64_tr_b16 v[60:61], v6 offset:8192
    ds_read_b64_tr_b16 v[62:63], v6 offset:8704
    s_waitcnt lgkmcnt(12)
    v_mfma_f32_16x16x32_bf16 v[144:147], v[36:39], v[96:99], v[144:147]
    s_waitcnt vmcnt(12)
    ds_read_b128 v[64:67], v1 offset:28672
    ds_read_b128 v[68:71], v2 offset:28672
    v_mfma_f32_16x16x32_bf16 v[148:151], v[36:39], v[104:107], v[148:151]
    ds_read_b128 v[72:75], v1 offset:30720
    s_waitcnt lgkmcnt(11)
    ds_read_b128 v[76:79], v2 offset:30720
    v_mfma_f32_16x16x32_bf16 v[152:155], v[36:39], v[112:115], v[152:155]
    v_mfma_f32_16x16x32_bf16 v[156:159], v[36:39], v[120:123], v[156:159]
    v_mfma_f32_16x16x32_bf16 v[160:163], v[40:43], v[96:99], v[160:163]
    v_mfma_f32_16x16x32_bf16 v[164:167], v[40:43], v[104:107], v[164:167]
    v_mfma_f32_16x16x32_bf16 v[168:171], v[40:43], v[112:115], v[168:171]
    s_waitcnt lgkmcnt(0)
    s_add_u32 m0, s6, 20480
    s_lshl_b32 s8, s70, 17
    s_add_u32 s8, s8, s78
    buffer_load_dwordx4 v12, s[48:51], s8 offen offset:0 lds
    v_mfma_f32_16x16x32_bf16 v[172:175], v[40:43], v[120:123], v[172:175]
    buffer_load_dwordx4 v13, s[48:51], s8 offen offset:1024 lds
    buffer_load_dwordx4 v14, s[48:51], s8 offen offset:2048 lds
    buffer_load_dwordx4 v15, s[48:51], s8 offen offset:3072 lds
    v_lshl_add_u32 v16, v16, 8, v8
    v_mfma_f32_16x16x32_bf16 v[176:179], v[44:47], v[96:99], v[176:179]
    v_lshl_add_u32 v17, v17, 8, v9
    v_lshl_add_u32 v18, v18, 8, v10
    v_lshl_add_u32 v19, v19, 8, v11
    s_add_u32 m0, s6, 28672
    s_nop 0
    v_mfma_f32_16x16x32_bf16 v[180:183], v[44:47], v[104:107], v[180:183]
    buffer_load_dwordx4 v16, s[44:47], 0 offen offset:0  lds
    buffer_load_dwordx4 v17, s[44:47], 0 offen offset:1024  lds
    buffer_load_dwordx4 v18, s[44:47], 0 offen offset:2048  lds
    buffer_load_dwordx4 v19, s[44:47], 0 offen offset:3072  lds
    s_lshl_b32 s9, s72, 2
    v_mfma_f32_16x16x32_bf16 v[184:187], v[44:47], v[112:115], v[184:187]
    v_add_u32 v30, s9, v7
    ds_read_b32 v16, v30 offset:0
    ds_read_b32 v17, v30 offset:832
    ds_read_b32 v18, v30 offset:1664
    ds_read_b32 v19, v30 offset:2496
    v_mfma_f32_16x16x32_bf16 v[188:191], v[44:47], v[120:123], v[188:191]
    v_mfma_f32_16x16x32_bf16 v[128:131], v[48:51], v[100:103], v[128:131]
    s_waitcnt vmcnt(16)
    ds_read_b64_tr_b16 v[32:33], v3 offset:12288
    ds_read_b64_tr_b16 v[34:35], v3 offset:12800
    v_mfma_f32_16x16x32_bf16 v[132:135], v[48:51], v[108:111], v[132:135]
    ds_read_b64_tr_b16 v[36:37], v4 offset:12288
    ds_read_b64_tr_b16 v[38:39], v4 offset:12800
    v_mfma_f32_16x16x32_bf16 v[136:139], v[48:51], v[116:119], v[136:139]
    ds_read_b64_tr_b16 v[40:41], v5 offset:12288
    ds_read_b64_tr_b16 v[42:43], v5 offset:12800
    v_mfma_f32_16x16x32_bf16 v[140:143], v[48:51], v[124:127], v[140:143]
    ds_read_b64_tr_b16 v[44:45], v6 offset:12288
    ds_read_b64_tr_b16 v[46:47], v6 offset:12800
    v_mfma_f32_16x16x32_bf16 v[144:147], v[52:55], v[100:103], v[144:147]
    s_waitcnt vmcnt(12)
    ds_read_b128 v[80:83], v1 offset:32768
    ds_read_b128 v[84:87], v2 offset:32768
    v_mfma_f32_16x16x32_bf16 v[148:151], v[52:55], v[108:111], v[148:151]
    ds_read_b128 v[88:91], v1 offset:34816
    s_waitcnt lgkmcnt(11)
    ds_read_b128 v[92:95], v2 offset:34816
    v_mfma_f32_16x16x32_bf16 v[152:155], v[52:55], v[116:119], v[152:155]
    v_mfma_f32_16x16x32_bf16 v[156:159], v[52:55], v[124:127], v[156:159]
    v_mfma_f32_16x16x32_bf16 v[160:163], v[56:59], v[100:103], v[160:163]
    v_mfma_f32_16x16x32_bf16 v[164:167], v[56:59], v[108:111], v[164:167]
    v_mfma_f32_16x16x32_bf16 v[168:171], v[56:59], v[116:119], v[168:171]
    s_waitcnt lgkmcnt(0)
    s_add_u32 m0, s6, 24576
    s_lshl_b32 s8, s70, 17
    s_add_u32 s8, s8, s78
    s_add_u32 s8, s8, 32768
    buffer_load_dwordx4 v12, s[48:51], s8 offen offset:0 lds
    v_mfma_f32_16x16x32_bf16 v[172:175], v[56:59], v[124:127], v[172:175]
    buffer_load_dwordx4 v13, s[48:51], s8 offen offset:1024 lds
    buffer_load_dwordx4 v14, s[48:51], s8 offen offset:2048 lds
    buffer_load_dwordx4 v15, s[48:51], s8 offen offset:3072 lds
    v_lshl_add_u32 v20, v20, 8, v8
    v_lshl_add_u32 v21, v21, 8, v9
    v_mfma_f32_16x16x32_bf16 v[176:179], v[60:63], v[100:103], v[176:179]
    v_lshl_add_u32 v22, v22, 8, v10
    v_lshl_add_u32 v23, v23, 8, v11
    s_add_u32 m0, s6, 32768
    s_nop 0
    buffer_load_dwordx4 v20, s[44:47], 0 offen offset:0  lds
    buffer_load_dwordx4 v21, s[44:47], 0 offen offset:1024  lds
    v_mfma_f32_16x16x32_bf16 v[180:183], v[60:63], v[108:111], v[180:183]
    buffer_load_dwordx4 v22, s[44:47], 0 offen offset:2048  lds
    buffer_load_dwordx4 v23, s[44:47], 0 offen offset:3072  lds
    s_lshl_b32 s9, s72, 2
    v_add_u32 v30, s9, v7
    ds_read_b32 v20, v30 offset:3328
    ds_read_b32 v21, v30 offset:4160
    v_mfma_f32_16x16x32_bf16 v[184:187], v[60:63], v[116:119], v[184:187]
    ds_read_b32 v22, v30 offset:4992
    ds_read_b32 v23, v30 offset:5824
    v_mfma_f32_16x16x32_bf16 v[188:191], v[60:63], v[124:127], v[188:191]
    s_cmp_lg_u32 s77, 6
    s_cbranch_scc1 L_nf6
    s_mov_b64 exec, 1
    buffer_store_byte v24, off, s[56:59], s13 sc1
    s_mov_b64 exec, -1
L_nf6:
    v_mfma_f32_16x16x32_bf16 v[192:195], v[32:35], v[64:67], v[192:195]
    s_waitcnt vmcnt(16)
    ds_read_b64_tr_b16 v[48:49], v3 offset:16384
    ds_read_b64_tr_b16 v[50:51], v3 offset:16896
    v_mfma_f32_16x16x32_bf16 v[196:199], v[32:35], v[72:75], v[196:199]
    ds_read_b64_tr_b16 v[52:53], v4 offset:16384
    ds_read_b64_tr_b16 v[54:55], v4 offset:16896
    v_mfma_f32_16x16x32_bf16 v[200:203], v[32:35], v[80:83], v[200:203]
    ds_read_b64_tr_b16 v[56:57], v5 offset:16384
    ds_read_b64_tr_b16 v[58:59], v5 offset:16896
    v_mfma_f32_16x16x32_bf16 v[204:207], v[32:35], v[88:91], v[204:207]
    ds_read_b64_tr_b16 v[60:61], v6 offset:16384
    ds_read_b64_tr_b16 v[62:63], v6 offset:16896
    v_mfma_f32_16x16x32_bf16 v[208:211], v[36:39], v[64:67], v[208:211]
    v_mfma_f32_16x16x32_bf16 v[212:215], v[36:39], v[72:75], v[212:215]
    v_mfma_f32_16x16x32_bf16 v[216:219], v[36:39], v[80:83], v[216:219]
    v_mfma_f32_16x16x32_bf16 v[220:223], v[36:39], v[88:91], v[220:223]
    v_mfma_f32_16x16x32_bf16 v[224:227], v[40:43], v[64:67], v[224:227]
    v_mfma_f32_16x16x32_bf16 v[228:231], v[40:43], v[72:75], v[228:231]
    v_mfma_f32_16x16x32_bf16 v[232:235], v[40:43], v[80:83], v[232:235]
    s_waitcnt lgkmcnt(0)
    s_add_u32 m0, s6, 0
    v_mfma_f32_16x16x32_bf16 v[236:239], v[40:43], v[88:91], v[236:239]
    s_lshl_b32 s8, s71, 17
    s_add_u32 s8, s8, s79
    v_mfma_f32_16x16x32_bf16 v[240:243], v[44:47], v[64:67], v[240:243]
    buffer_load_dwordx4 v12, s[48:51], s8 offen offset:0 lds
    buffer_load_dwordx4 v13, s[48:51], s8 offen offset:1024 lds
    v_mfma_f32_16x16x32_bf16 v[244:247], v[44:47], v[72:75], v[244:247]
    buffer_load_dwordx4 v14, s[48:51], s8 offen offset:2048 lds
    buffer_load_dwordx4 v15, s[48:51], s8 offen offset:3072 lds
    v_mfma_f32_16x16x32_bf16 v[248:251], v[44:47], v[80:83], v[248:251]
    v_mfma_f32_16x16x32_bf16 v[252:255], v[44:47], v[88:91], v[252:255]
    v_mfma_f32_16x16x32_bf16 v[192:195], v[48:51], v[68:71], v[192:195]
    s_waitcnt vmcnt(16)
    ds_read_b64_tr_b16 v[32:33], v3 offset:20480
    ds_read_b64_tr_b16 v[34:35], v3 offset:20992
    v_mfma_f32_16x16x32_bf16 v[196:199], v[48:51], v[76:79], v[196:199]
    ds_read_b64_tr_b16 v[36:37], v4 offset:20480
    ds_read_b64_tr_b16 v[38:39], v4 offset:20992
    v_mfma_f32_16x16x32_bf16 v[200:203], v[48:51], v[84:87], v[200:203]
    ds_read_b64_tr_b16 v[40:41], v5 offset:20480
    ds_read_b64_tr_b16 v[42:43], v5 offset:20992
    v_mfma_f32_16x16x32_bf16 v[204:207], v[48:51], v[92:95], v[204:207]
    ds_read_b64_tr_b16 v[44:45], v6 offset:20480
    ds_read_b64_tr_b16 v[46:47], v6 offset:20992
    v_mfma_f32_16x16x32_bf16 v[208:211], v[52:55], v[68:71], v[208:211]
    v_mfma_f32_16x16x32_bf16 v[212:215], v[52:55], v[76:79], v[212:215]
    v_mfma_f32_16x16x32_bf16 v[216:219], v[52:55], v[84:87], v[216:219]
    v_mfma_f32_16x16x32_bf16 v[220:223], v[52:55], v[92:95], v[220:223]
    v_mfma_f32_16x16x32_bf16 v[224:227], v[56:59], v[68:71], v[224:227]
    v_mfma_f32_16x16x32_bf16 v[228:231], v[56:59], v[76:79], v[228:231]
    v_mfma_f32_16x16x32_bf16 v[232:235], v[56:59], v[84:87], v[232:235]
    s_waitcnt lgkmcnt(0)
    s_add_u32 m0, s6, 4096
    v_mfma_f32_16x16x32_bf16 v[236:239], v[56:59], v[92:95], v[236:239]
    s_lshl_b32 s8, s71, 17
    s_add_u32 s8, s8, s79
    v_mfma_f32_16x16x32_bf16 v[240:243], v[60:63], v[68:71], v[240:243]
    s_add_u32 s8, s8, 32768
    buffer_load_dwordx4 v12, s[48:51], s8 offen offset:0 lds
    v_mfma_f32_16x16x32_bf16 v[244:247], v[60:63], v[76:79], v[244:247]
    buffer_load_dwordx4 v13, s[48:51], s8 offen offset:1024 lds
    buffer_load_dwordx4 v14, s[48:51], s8 offen offset:2048 lds
    v_mfma_f32_16x16x32_bf16 v[248:251], v[60:63], v[84:87], v[248:251]
    buffer_load_dwordx4 v15, s[48:51], s8 offen offset:3072 lds
    v_mfma_f32_16x16x32_bf16 v[252:255], v[60:63], v[92:95], v[252:255]
    v_mfma_f32_16x16x32_bf16 v[128:131], v[32:35], v[64:67], v[128:131]
    s_waitcnt vmcnt(12)
    ds_read_b64_tr_b16 v[48:49], v3 offset:24576
    ds_read_b64_tr_b16 v[50:51], v3 offset:25088
    v_mfma_f32_16x16x32_bf16 v[132:135], v[32:35], v[72:75], v[132:135]
    ds_read_b64_tr_b16 v[52:53], v4 offset:24576
    ds_read_b64_tr_b16 v[54:55], v4 offset:25088
    v_mfma_f32_16x16x32_bf16 v[136:139], v[32:35], v[80:83], v[136:139]
    ds_read_b64_tr_b16 v[56:57], v5 offset:24576
    ds_read_b64_tr_b16 v[58:59], v5 offset:25088
    v_mfma_f32_16x16x32_bf16 v[140:143], v[32:35], v[88:91], v[140:143]
    ds_read_b64_tr_b16 v[60:61], v6 offset:24576
    ds_read_b64_tr_b16 v[62:63], v6 offset:25088
    v_mfma_f32_16x16x32_bf16 v[144:147], v[36:39], v[64:67], v[144:147]
    ds_read_b128 v[96:99], v1 offset:28672
    ds_read_b128 v[100:103], v2 offset:28672
    v_mfma_f32_16x16x32_bf16 v[148:151], v[36:39], v[72:75], v[148:151]
    ds_read_b128 v[104:107], v1 offset:30720
    ds_read_b128 v[108:111], v2 offset:30720
    v_mfma_f32_16x16x32_bf16 v[152:155], v[36:39], v[80:83], v[152:155]
    v_mfma_f32_16x16x32_bf16 v[156:159], v[36:39], v[88:91], v[156:159]
    v_mfma_f32_16x16x32_bf16 v[160:163], v[40:43], v[64:67], v[160:163]
    v_mfma_f32_16x16x32_bf16 v[164:167], v[40:43], v[72:75], v[164:167]
    v_mfma_f32_16x16x32_bf16 v[168:171], v[40:43], v[80:83], v[168:171]
    s_waitcnt lgkmcnt(0)
    s_add_u32 m0, s6, 8192
    s_lshl_b32 s8, s71, 17
    s_add_u32 s8, s8, s78
    buffer_load_dwordx4 v12, s[48:51], s8 offen offset:0 lds
    v_mfma_f32_16x16x32_bf16 v[172:175], v[40:43], v[88:91], v[172:175]
    buffer_load_dwordx4 v13, s[48:51], s8 offen offset:1024 lds
    buffer_load_dwordx4 v14, s[48:51], s8 offen offset:2048 lds
    buffer_load_dwordx4 v15, s[48:51], s8 offen offset:3072 lds
    v_lshl_add_u32 v16, v16, 8, v8
    v_mfma_f32_16x16x32_bf16 v[176:179], v[44:47], v[64:67], v[176:179]
    v_lshl_add_u32 v17, v17, 8, v9
    v_lshl_add_u32 v18, v18, 8, v10
    v_lshl_add_u32 v19, v19, 8, v11
    s_add_u32 m0, s6, 28672
    s_nop 0
    v_mfma_f32_16x16x32_bf16 v[180:183], v[44:47], v[72:75], v[180:183]
    buffer_load_dwordx4 v16, s[44:47], 0 offen offset:0  lds
    buffer_load_dwordx4 v17, s[44:47], 0 offen offset:1024  lds
    buffer_load_dwordx4 v18, s[44:47], 0 offen offset:2048  lds
    buffer_load_dwordx4 v19, s[44:47], 0 offen offset:3072  lds
    s_lshl_b32 s9, s73, 2
    v_mfma_f32_16x16x32_bf16 v[184:187], v[44:47], v[80:83], v[184:187]
    v_add_u32 v30, s9, v7
    ds_read_b32 v16, v30 offset:0
    ds_read_b32 v17, v30 offset:832
    ds_read_b32 v18, v30 offset:1664
    ds_read_b32 v19, v30 offset:2496
    v_mfma_f32_16x16x32_bf16 v[188:191], v[44:47], v[88:91], v[188:191]
    v_mfma_f32_16x16x32_bf16 v[128:131], v[48:51], v[68:71], v[128:131]
    s_waitcnt vmcnt(12)
    ds_read_b64_tr_b16 v[32:33], v3 offset:0
    ds_read_b64_tr_b16 v[34:35], v3 offset:512
    v_mfma_f32_16x16x32_bf16 v[132:135], v[48:51], v[76:79], v[132:135]
    ds_read_b64_tr_b16 v[36:37], v4 offset:0
    ds_read_b64_tr_b16 v[38:39], v4 offset:512
    v_mfma_f32_16x16x32_bf16 v[136:139], v[48:51], v[84:87], v[136:139]
    ds_read_b64_tr_b16 v[40:41], v5 offset:0
    ds_read_b64_tr_b16 v[42:43], v5 offset:512
    v_mfma_f32_16x16x32_bf16 v[140:143], v[48:51], v[92:95], v[140:143]
    ds_read_b64_tr_b16 v[44:45], v6 offset:0
    ds_read_b64_tr_b16 v[46:47], v6 offset:512
    v_mfma_f32_16x16x32_bf16 v[144:147], v[52:55], v[68:71], v[144:147]
    ds_read_b128 v[112:115], v1 offset:32768
    ds_read_b128 v[116:119], v2 offset:32768
    v_mfma_f32_16x16x32_bf16 v[148:151], v[52:55], v[76:79], v[148:151]
    ds_read_b128 v[120:123], v1 offset:34816
    s_waitcnt lgkmcnt(11)
    ds_read_b128 v[124:127], v2 offset:34816
    v_mfma_f32_16x16x32_bf16 v[152:155], v[52:55], v[84:87], v[152:155]
    v_mfma_f32_16x16x32_bf16 v[156:159], v[52:55], v[92:95], v[156:159]
    v_mfma_f32_16x16x32_bf16 v[160:163], v[56:59], v[68:71], v[160:163]
    v_mfma_f32_16x16x32_bf16 v[164:167], v[56:59], v[76:79], v[164:167]
    v_mfma_f32_16x16x32_bf16 v[168:171], v[56:59], v[84:87], v[168:171]
    s_waitcnt lgkmcnt(0)
    s_add_u32 m0, s6, 12288
    s_lshl_b32 s8, s71, 17
    s_add_u32 s8, s8, s78
    s_add_u32 s8, s8, 32768
    buffer_load_dwordx4 v12, s[48:51], s8 offen offset:0 lds
    v_mfma_f32_16x16x32_bf16 v[172:175], v[56:59], v[92:95], v[172:175]
    buffer_load_dwordx4 v13, s[48:51], s8 offen offset:1024 lds
    buffer_load_dwordx4 v14, s[48:51], s8 offen offset:2048 lds
    buffer_load_dwordx4 v15, s[48:51], s8 offen offset:3072 lds
    v_lshl_add_u32 v20, v20, 8, v8
    v_lshl_add_u32 v21, v21, 8, v9
    v_mfma_f32_16x16x32_bf16 v[176:179], v[60:63], v[68:71], v[176:179]
    v_lshl_add_u32 v22, v22, 8, v10
    v_lshl_add_u32 v23, v23, 8, v11
    s_add_u32 m0, s6, 32768
    s_nop 0
    buffer_load_dwordx4 v20, s[44:47], 0 offen offset:0  lds
    buffer_load_dwordx4 v21, s[44:47], 0 offen offset:1024  lds
    v_mfma_f32_16x16x32_bf16 v[180:183], v[60:63], v[76:79], v[180:183]
    buffer_load_dwordx4 v22, s[44:47], 0 offen offset:2048  lds
    buffer_load_dwordx4 v23, s[44:47], 0 offen offset:3072  lds
    s_lshl_b32 s9, s73, 2
    v_add_u32 v30, s9, v7
    ds_read_b32 v20, v30 offset:3328
    ds_read_b32 v21, v30 offset:4160
    v_mfma_f32_16x16x32_bf16 v[184:187], v[60:63], v[84:87], v[184:187]
    ds_read_b32 v22, v30 offset:4992
    ds_read_b32 v23, v30 offset:5824
    v_mfma_f32_16x16x32_bf16 v[188:191], v[60:63], v[92:95], v[188:191]
    s_cmp_lg_u32 s77, 7
    s_cbranch_scc1 L_nf7
    s_mov_b64 exec, 1
    buffer_store_byte v24, off, s[56:59], s13 sc1
    s_mov_b64 exec, -1
L_nf7:
    v_mfma_f32_16x16x32_bf16 v[192:195], v[32:35], v[96:99], v[192:195]
    s_waitcnt vmcnt(16)
    ds_read_b64_tr_b16 v[48:49], v3 offset:4096
    ds_read_b64_tr_b16 v[50:51], v3 offset:4608
    v_mfma_f32_16x16x32_bf16 v[196:199], v[32:35], v[104:107], v[196:199]
    ds_read_b64_tr_b16 v[52:53], v4 offset:4096
    ds_read_b64_tr_b16 v[54:55], v4 offset:4608
    v_mfma_f32_16x16x32_bf16 v[200:203], v[32:35], v[112:115], v[200:203]
    ds_read_b64_tr_b16 v[56:57], v5 offset:4096
    ds_read_b64_tr_b16 v[58:59], v5 offset:4608
    v_mfma_f32_16x16x32_bf16 v[204:207], v[32:35], v[120:123], v[204:207]
    ds_read_b64_tr_b16 v[60:61], v6 offset:4096
    ds_read_b64_tr_b16 v[62:63], v6 offset:4608
    v_mfma_f32_16x16x32_bf16 v[208:211], v[36:39], v[96:99], v[208:211]
    v_mfma_f32_16x16x32_bf16 v[212:215], v[36:39], v[104:107], v[212:215]
    v_mfma_f32_16x16x32_bf16 v[216:219], v[36:39], v[112:115], v[216:219]
    v_mfma_f32_16x16x32_bf16 v[220:223], v[36:39], v[120:123], v[220:223]
    v_mfma_f32_16x16x32_bf16 v[224:227], v[40:43], v[96:99], v[224:227]
    v_mfma_f32_16x16x32_bf16 v[228:231], v[40:43], v[104:107], v[228:231]
    v_mfma_f32_16x16x32_bf16 v[232:235], v[40:43], v[112:115], v[232:235]
    s_waitcnt lgkmcnt(0)
    s_add_u32 m0, s6, 16384
    v_mfma_f32_16x16x32_bf16 v[236:239], v[40:43], v[120:123], v[236:239]
    s_lshl_b32 s8, s72, 17
    s_add_u32 s8, s8, s79
    v_mfma_f32_16x16x32_bf16 v[240:243], v[44:47], v[96:99], v[240:243]
    buffer_load_dwordx4 v12, s[48:51], s8 offen offset:0 lds
    buffer_load_dwordx4 v13, s[48:51], s8 offen offset:1024 lds
    v_mfma_f32_16x16x32_bf16 v[244:247], v[44:47], v[104:107], v[244:247]
    buffer_load_dwordx4 v14, s[48:51], s8 offen offset:2048 lds
    buffer_load_dwordx4 v15, s[48:51], s8 offen offset:3072 lds
    v_mfma_f32_16x16x32_bf16 v[248:251], v[44:47], v[112:115], v[248:251]
    v_mfma_f32_16x16x32_bf16 v[252:255], v[44:47], v[120:123], v[252:255]
    v_mfma_f32_16x16x32_bf16 v[192:195], v[48:51], v[100:103], v[192:195]
    s_waitcnt vmcnt(16)
    ds_read_b64_tr_b16 v[32:33], v3 offset:8192
    ds_read_b64_tr_b16 v[34:35], v3 offset:8704
    v_mfma_f32_16x16x32_bf16 v[196:199], v[48:51], v[108:111], v[196:199]
    ds_read_b64_tr_b16 v[36:37], v4 offset:8192
    ds_read_b64_tr_b16 v[38:39], v4 offset:8704
    v_mfma_f32_16x16x32_bf16 v[200:203], v[48:51], v[116:119], v[200:203]
    ds_read_b64_tr_b16 v[40:41], v5 offset:8192
    ds_read_b64_tr_b16 v[42:43], v5 offset:8704
    v_mfma_f32_16x16x32_bf16 v[204:207], v[48:51], v[124:127], v[204:207]
    ds_read_b64_tr_b16 v[44:45], v6 offset:8192
    ds_read_b64_tr_b16 v[46:47], v6 offset:8704
    v_mfma_f32_16x16x32_bf16 v[208:211], v[52:55], v[100:103], v[208:211]
    v_mfma_f32_16x16x32_bf16 v[212:215], v[52:55], v[108:111], v[212:215]
    v_mfma_f32_16x16x32_bf16 v[216:219], v[52:55], v[116:119], v[216:219]
    v_mfma_f32_16x16x32_bf16 v[220:223], v[52:55], v[124:127], v[220:223]
    v_mfma_f32_16x16x32_bf16 v[224:227], v[56:59], v[100:103], v[224:227]
    v_mfma_f32_16x16x32_bf16 v[228:231], v[56:59], v[108:111], v[228:231]
    v_mfma_f32_16x16x32_bf16 v[232:235], v[56:59], v[116:119], v[232:235]
    s_waitcnt lgkmcnt(0)
    s_add_u32 m0, s6, 20480
    v_mfma_f32_16x16x32_bf16 v[236:239], v[56:59], v[124:127], v[236:239]
    s_lshl_b32 s8, s72, 17
    s_add_u32 s8, s8, s79
    v_mfma_f32_16x16x32_bf16 v[240:243], v[60:63], v[100:103], v[240:243]
    s_add_u32 s8, s8, 32768
    buffer_load_dwordx4 v12, s[48:51], s8 offen offset:0 lds
    v_mfma_f32_16x16x32_bf16 v[244:247], v[60:63], v[108:111], v[244:247]
    buffer_load_dwordx4 v13, s[48:51], s8 offen offset:1024 lds
    buffer_load_dwordx4 v14, s[48:51], s8 offen offset:2048 lds
    v_mfma_f32_16x16x32_bf16 v[248:251], v[60:63], v[116:119], v[248:251]
    buffer_load_dwordx4 v15, s[48:51], s8 offen offset:3072 lds
    v_mfma_f32_16x16x32_bf16 v[252:255], v[60:63], v[124:127], v[252:255]
    v_mfma_f32_16x16x32_bf16 v[128:131], v[32:35], v[96:99], v[128:131]
    s_waitcnt vmcnt(12)
    ds_read_b64_tr_b16 v[48:49], v3 offset:12288
    ds_read_b64_tr_b16 v[50:51], v3 offset:12800
    v_mfma_f32_16x16x32_bf16 v[132:135], v[32:35], v[104:107], v[132:135]
    ds_read_b64_tr_b16 v[52:53], v4 offset:12288
    ds_read_b64_tr_b16 v[54:55], v4 offset:12800
    v_mfma_f32_16x16x32_bf16 v[136:139], v[32:35], v[112:115], v[136:139]
    ds_read_b64_tr_b16 v[56:57], v5 offset:12288
    ds_read_b64_tr_b16 v[58:59], v5 offset:12800
    v_mfma_f32_16x16x32_bf16 v[140:143], v[32:35], v[120:123], v[140:143]
    ds_read_b64_tr_b16 v[60:61], v6 offset:12288
    ds_read_b64_tr_b16 v[62:63], v6 offset:12800
    v_mfma_f32_16x16x32_bf16 v[144:147], v[36:39], v[96:99], v[144:147]
    ds_read_b128 v[64:67], v1 offset:28672
    ds_read_b128 v[68:71], v2 offset:28672
    v_mfma_f32_16x16x32_bf16 v[148:151], v[36:39], v[104:107], v[148:151]
    ds_read_b128 v[72:75], v1 offset:30720
    ds_read_b128 v[76:79], v2 offset:30720
    v_mfma_f32_16x16x32_bf16 v[152:155], v[36:39], v[112:115], v[152:155]
    v_mfma_f32_16x16x32_bf16 v[156:159], v[36:39], v[120:123], v[156:159]
    v_mfma_f32_16x16x32_bf16 v[160:163], v[40:43], v[96:99], v[160:163]
    v_mfma_f32_16x16x32_bf16 v[164:167], v[40:43], v[104:107], v[164:167]
    v_mfma_f32_16x16x32_bf16 v[168:171], v[40:43], v[112:115], v[168:171]
    s_waitcnt lgkmcnt(0)
    s_add_u32 m0, s6, 24576
    s_lshl_b32 s8, s72, 17
    s_add_u32 s8, s8, s78
    buffer_load_dwordx4 v12, s[48:51], s8 offen offset:0 lds
    v_mfma_f32_16x16x32_bf16 v[172:175], v[40:43], v[120:123], v[172:175]
    buffer_load_dwordx4 v13, s[48:51], s8 offen offset:1024 lds
    buffer_load_dwordx4 v14, s[48:51], s8 offen offset:2048 lds
    buffer_load_dwordx4 v15, s[48:51], s8 offen offset:3072 lds
    v_lshl_add_u32 v16, v16, 8, v8
    v_mfma_f32_16x16x32_bf16 v[176:179], v[44:47], v[96:99], v[176:179]
    v_lshl_add_u32 v17, v17, 8, v9
    v_lshl_add_u32 v18, v18, 8, v10
    v_lshl_add_u32 v19, v19, 8, v11
    s_add_u32 m0, s6, 28672
    s_nop 0
    v_mfma_f32_16x16x32_bf16 v[180:183], v[44:47], v[104:107], v[180:183]
    buffer_load_dwordx4 v16, s[44:47], 0 offen offset:0  lds
    buffer_load_dwordx4 v17, s[44:47], 0 offen offset:1024  lds
    buffer_load_dwordx4 v18, s[44:47], 0 offen offset:2048  lds
    buffer_load_dwordx4 v19, s[44:47], 0 offen offset:3072  lds
    s_lshl_b32 s9, s74, 2
    v_mfma_f32_16x16x32_bf16 v[184:187], v[44:47], v[112:115], v[184:187]
    v_add_u32 v30, s9, v7
    ds_read_b32 v16, v30 offset:0
    ds_read_b32 v17, v30 offset:832
    ds_read_b32 v18, v30 offset:1664
    ds_read_b32 v19, v30 offset:2496
    v_mfma_f32_16x16x32_bf16 v[188:191], v[44:47], v[120:123], v[188:191]
    v_mfma_f32_16x16x32_bf16 v[128:131], v[48:51], v[100:103], v[128:131]
    s_waitcnt vmcnt(12)
    ds_read_b64_tr_b16 v[32:33], v3 offset:16384
    ds_read_b64_tr_b16 v[34:35], v3 offset:16896
    v_mfma_f32_16x16x32_bf16 v[132:135], v[48:51], v[108:111], v[132:135]
    ds_read_b64_tr_b16 v[36:37], v4 offset:16384
    ds_read_b64_tr_b16 v[38:39], v4 offset:16896
    v_mfma_f32_16x16x32_bf16 v[136:139], v[48:51], v[116:119], v[136:139]
    ds_read_b64_tr_b16 v[40:41], v5 offset:16384
    ds_read_b64_tr_b16 v[42:43], v5 offset:16896
    v_mfma_f32_16x16x32_bf16 v[140:143], v[48:51], v[124:127], v[140:143]
    ds_read_b64_tr_b16 v[44:45], v6 offset:16384
    ds_read_b64_tr_b16 v[46:47], v6 offset:16896
    v_mfma_f32_16x16x32_bf16 v[144:147], v[52:55], v[100:103], v[144:147]
    ds_read_b128 v[80:83], v1 offset:32768
    ds_read_b128 v[84:87], v2 offset:32768
    v_mfma_f32_16x16x32_bf16 v[148:151], v[52:55], v[108:111], v[148:151]
    ds_read_b128 v[88:91], v1 offset:34816
    s_waitcnt lgkmcnt(11)
    ds_read_b128 v[92:95], v2 offset:34816
    v_mfma_f32_16x16x32_bf16 v[152:155], v[52:55], v[116:119], v[152:155]
    v_mfma_f32_16x16x32_bf16 v[156:159], v[52:55], v[124:127], v[156:159]
    v_mfma_f32_16x16x32_bf16 v[160:163], v[56:59], v[100:103], v[160:163]
    v_mfma_f32_16x16x32_bf16 v[164:167], v[56:59], v[108:111], v[164:167]
    v_mfma_f32_16x16x32_bf16 v[168:171], v[56:59], v[116:119], v[168:171]
    s_waitcnt lgkmcnt(0)
    s_add_u32 m0, s6, 0
    s_lshl_b32 s8, s72, 17
    s_add_u32 s8, s8, s78
    s_add_u32 s8, s8, 32768
    buffer_load_dwordx4 v12, s[48:51], s8 offen offset:0 lds
    v_mfma_f32_16x16x32_bf16 v[172:175], v[56:59], v[124:127], v[172:175]
    buffer_load_dwordx4 v13, s[48:51], s8 offen offset:1024 lds
    buffer_load_dwordx4 v14, s[48:51], s8 offen offset:2048 lds
    buffer_load_dwordx4 v15, s[48:51], s8 offen offset:3072 lds
    v_lshl_add_u32 v20, v20, 8, v8
    v_lshl_add_u32 v21, v21, 8, v9
    v_mfma_f32_16x16x32_bf16 v[176:179], v[60:63], v[100:103], v[176:179]
    v_lshl_add_u32 v22, v22, 8, v10
    v_lshl_add_u32 v23, v23, 8, v11
    s_add_u32 m0, s6, 32768
    s_nop 0
    buffer_load_dwordx4 v20, s[44:47], 0 offen offset:0  lds
    buffer_load_dwordx4 v21, s[44:47], 0 offen offset:1024  lds
    v_mfma_f32_16x16x32_bf16 v[180:183], v[60:63], v[108:111], v[180:183]
    buffer_load_dwordx4 v22, s[44:47], 0 offen offset:2048  lds
    buffer_load_dwordx4 v23, s[44:47], 0 offen offset:3072  lds
    s_lshl_b32 s9, s74, 2
    v_add_u32 v30, s9, v7
    ds_read_b32 v20, v30 offset:3328
    ds_read_b32 v21, v30 offset:4160
    v_mfma_f32_16x16x32_bf16 v[184:187], v[60:63], v[116:119], v[184:187]
    ds_read_b32 v22, v30 offset:4992
    ds_read_b32 v23, v30 offset:5824
    v_mfma_f32_16x16x32_bf16 v[188:191], v[60:63], v[124:127], v[188:191]
    s_cmp_lg_u32 s77, 8
    s_cbranch_scc1 L_nf8
    s_mov_b64 exec, 1
    buffer_store_byte v24, off, s[56:59], s13 sc1
    s_mov_b64 exec, -1
L_nf8:
    v_mfma_f32_16x16x32_bf16 v[192:195], v[32:35], v[64:67], v[192:195]
    s_waitcnt vmcnt(16)
    ds_read_b64_tr_b16 v[48:49], v3 offset:20480
    ds_read_b64_tr_b16 v[50:51], v3 offset:20992
    v_mfma_f32_16x16x32_bf16 v[196:199], v[32:35], v[72:75], v[196:199]
    ds_read_b64_tr_b16 v[52:53], v4 offset:20480
    ds_read_b64_tr_b16 v[54:55], v4 offset:20992
    v_mfma_f32_16x16x32_bf16 v[200:203], v[32:35], v[80:83], v[200:203]
    ds_read_b64_tr_b16 v[56:57], v5 offset:20480
    ds_read_b64_tr_b16 v[58:59], v5 offset:20992
    v_mfma_f32_16x16x32_bf16 v[204:207], v[32:35], v[88:91], v[204:207]
    ds_read_b64_tr_b16 v[60:61], v6 offset:20480
    ds_read_b64_tr_b16 v[62:63], v6 offset:20992
    v_mfma_f32_16x16x32_bf16 v[208:211], v[36:39], v[64:67], v[208:211]
    v_mfma_f32_16x16x32_bf16 v[212:215], v[36:39], v[72:75], v[212:215]
    v_mfma_f32_16x16x32_bf16 v[216:219], v[36:39], v[80:83], v[216:219]
    v_mfma_f32_16x16x32_bf16 v[220:223], v[36:39], v[88:91], v[220:223]
    v_mfma_f32_16x16x32_bf16 v[224:227], v[40:43], v[64:67], v[224:227]
    v_mfma_f32_16x16x32_bf16 v[228:231], v[40:43], v[72:75], v[228:231]
    v_mfma_f32_16x16x32_bf16 v[232:235], v[40:43], v[80:83], v[232:235]
    s_waitcnt lgkmcnt(0)
    s_add_u32 m0, s6, 4096
    v_mfma_f32_16x16x32_bf16 v[236:239], v[40:43], v[88:91], v[236:239]
    s_lshl_b32 s8, s73, 17
    s_add_u32 s8, s8, s79
    v_mfma_f32_16x16x32_bf16 v[240:243], v[44:47], v[64:67], v[240:243]
    buffer_load_dwordx4 v12, s[48:51], s8 offen offset:0 lds
    buffer_load_dwordx4 v13, s[48:51], s8 offen offset:1024 lds
    v_mfma_f32_16x16x32_bf16 v[244:247], v[44:47], v[72:75], v[244:247]
    buffer_load_dwordx4 v14, s[48:51], s8 offen offset:2048 lds
    buffer_load_dwordx4 v15, s[48:51], s8 offen offset:3072 lds
    v_mfma_f32_16x16x32_bf16 v[248:251], v[44:47], v[80:83], v[248:251]
    v_mfma_f32_16x16x32_bf16 v[252:255], v[44:47], v[88:91], v[252:255]
    v_mfma_f32_16x16x32_bf16 v[192:195], v[48:51], v[68:71], v[192:195]
    s_waitcnt vmcnt(16)
    ds_read_b64_tr_b16 v[32:33], v3 offset:24576
    ds_read_b64_tr_b16 v[34:35], v3 offset:25088
    v_mfma_f32_16x16x32_bf16 v[196:199], v[48:51], v[76:79], v[196:199]
    ds_read_b64_tr_b16 v[36:37], v4 offset:24576
    ds_read_b64_tr_b16 v[38:39], v4 offset:25088
    v_mfma_f32_16x16x32_bf16 v[200:203], v[48:51], v[84:87], v[200:203]
    ds_read_b64_tr_b16 v[40:41], v5 offset:24576
    ds_read_b64_tr_b16 v[42:43], v5 offset:25088
    v_mfma_f32_16x16x32_bf16 v[204:207], v[48:51], v[92:95], v[204:207]
    ds_read_b64_tr_b16 v[44:45], v6 offset:24576
    ds_read_b64_tr_b16 v[46:47], v6 offset:25088
    v_mfma_f32_16x16x32_bf16 v[208:211], v[52:55], v[68:71], v[208:211]
    v_mfma_f32_16x16x32_bf16 v[212:215], v[52:55], v[76:79], v[212:215]
    v_mfma_f32_16x16x32_bf16 v[216:219], v[52:55], v[84:87], v[216:219]
    v_mfma_f32_16x16x32_bf16 v[220:223], v[52:55], v[92:95], v[220:223]
    v_mfma_f32_16x16x32_bf16 v[224:227], v[56:59], v[68:71], v[224:227]
    v_mfma_f32_16x16x32_bf16 v[228:231], v[56:59], v[76:79], v[228:231]
    v_mfma_f32_16x16x32_bf16 v[232:235], v[56:59], v[84:87], v[232:235]
    s_waitcnt lgkmcnt(0)
    s_add_u32 m0, s6, 8192
    v_mfma_f32_16x16x32_bf16 v[236:239], v[56:59], v[92:95], v[236:239]
    s_lshl_b32 s8, s73, 17
    s_add_u32 s8, s8, s79
    v_mfma_f32_16x16x32_bf16 v[240:243], v[60:63], v[68:71], v[240:243]
    s_add_u32 s8, s8, 32768
    buffer_load_dwordx4 v12, s[48:51], s8 offen offset:0 lds
    v_mfma_f32_16x16x32_bf16 v[244:247], v[60:63], v[76:79], v[244:247]
    buffer_load_dwordx4 v13, s[48:51], s8 offen offset:1024 lds
    buffer_load_dwordx4 v14, s[48:51], s8 offen offset:2048 lds
    v_mfma_f32_16x16x32_bf16 v[248:251], v[60:63], v[84:87], v[248:251]
    buffer_load_dwordx4 v15, s[48:51], s8 offen offset:3072 lds
    v_mfma_f32_16x16x32_bf16 v[252:255], v[60:63], v[92:95], v[252:255]
    v_mfma_f32_16x16x32_bf16 v[128:131], v[32:35], v[64:67], v[128:131]
    s_waitcnt vmcnt(12)
    ds_read_b64_tr_b16 v[48:49], v3 offset:0
    ds_read_b64_tr_b16 v[50:51], v3 offset:512
    v_mfma_f32_16x16x32_bf16 v[132:135], v[32:35], v[72:75], v[132:135]
    ds_read_b64_tr_b16 v[52:53], v4 offset:0
    ds_read_b64_tr_b16 v[54:55], v4 offset:512
    v_mfma_f32_16x16x32_bf16 v[136:139], v[32:35], v[80:83], v[136:139]
    ds_read_b64_tr_b16 v[56:57], v5 offset:0
    ds_read_b64_tr_b16 v[58:59], v5 offset:512
    v_mfma_f32_16x16x32_bf16 v[140:143], v[32:35], v[88:91], v[140:143]
    ds_read_b64_tr_b16 v[60:61], v6 offset:0
    ds_read_b64_tr_b16 v[62:63], v6 offset:512
    v_mfma_f32_16x16x32_bf16 v[144:147], v[36:39], v[64:67], v[144:147]
    ds_read_b128 v[96:99], v1 offset:28672
    ds_read_b128 v[100:103], v2 offset:28672
    v_mfma_f32_16x16x32_bf16 v[148:151], v[36:39], v[72:75], v[148:151]
    ds_read_b128 v[104:107], v1 offset:30720
    ds_read_b128 v[108:111], v2 offset:30720
    v_mfma_f32_16x16x32_bf16 v[152:155], v[36:39], v[80:83], v[152:155]
    v_mfma_f32_16x16x32_bf16 v[156:159], v[36:39], v[88:91], v[156:159]
    v_mfma_f32_16x16x32_bf16 v[160:163], v[40:43], v[64:67], v[160:163]
    v_mfma_f32_16x16x32_bf16 v[164:167], v[40:43], v[72:75], v[164:167]
    v_mfma_f32_16x16x32_bf16 v[168:171], v[40:43], v[80:83], v[168:171]
    s_waitcnt lgkmcnt(0)
    s_add_u32 m0, s6, 12288
    s_lshl_b32 s8, s73, 17
    s_add_u32 s8, s8, s78
    buffer_load_dwordx4 v12, s[48:51], s8 offen offset:0 lds
    v_mfma_f32_16x16x32_bf16 v[172:175], v[40:43], v[88:91], v[172:175]
    buffer_load_dwordx4 v13, s[48:51], s8 offen offset:1024 lds
    buffer_load_dwordx4 v14, s[48:51], s8 offen offset:2048 lds
    buffer_load_dwordx4 v15, s[48:51], s8 offen offset:3072 lds
    v_lshl_add_u32 v16, v16, 8, v8
    v_mfma_f32_16x16x32_bf16 v[176:179], v[44:47], v[64:67], v[176:179]
    v_lshl_add_u32 v17, v17, 8, v9
    v_lshl_add_u32 v18, v18, 8, v10
    v_lshl_add_u32 v19, v19, 8, v11
    s_add_u32 m0, s6, 28672
    s_nop 0
    v_mfma_f32_16x16x32_bf16 v[180:183], v[44:47], v[72:75], v[180:183]
    buffer_load_dwordx4 v16, s[44:47], 0 offen offset:0  lds
    buffer_load_dwordx4 v17, s[44:47], 0 offen offset:1024  lds
    buffer_load_dwordx4 v18, s[44:47], 0 offen offset:2048  lds
    buffer_load_dwordx4 v19, s[44:47], 0 offen offset:3072  lds
    s_lshl_b32 s9, s75, 2
    v_mfma_f32_16x16x32_bf16 v[184:187], v[44:47], v[80:83], v[184:187]
    v_add_u32 v30, s9, v7
    ds_read_b32 v16, v30 offset:0
    ds_read_b32 v17, v30 offset:832
    ds_read_b32 v18, v30 offset:1664
    ds_read_b32 v19, v30 offset:2496
    v_mfma_f32_16x16x32_bf16 v[188:191], v[44:47], v[88:91], v[188:191]
    v_mfma_f32_16x16x32_bf16 v[128:131], v[48:51], v[68:71], v[128:131]
    s_waitcnt vmcnt(12)
    ds_read_b64_tr_b16 v[32:33], v3 offset:4096
    ds_read_b64_tr_b16 v[34:35], v3 offset:4608
    v_mfma_f32_16x16x32_bf16 v[132:135], v[48:51], v[76:79], v[132:135]
    ds_read_b64_tr_b16 v[36:37], v4 offset:4096
    ds_read_b64_tr_b16 v[38:39], v4 offset:4608
    v_mfma_f32_16x16x32_bf16 v[136:139], v[48:51], v[84:87], v[136:139]
    ds_read_b64_tr_b16 v[40:41], v5 offset:4096
    ds_read_b64_tr_b16 v[42:43], v5 offset:4608
    v_mfma_f32_16x16x32_bf16 v[140:143], v[48:51], v[92:95], v[140:143]
    ds_read_b64_tr_b16 v[44:45], v6 offset:4096
    ds_read_b64_tr_b16 v[46:47], v6 offset:4608
    v_mfma_f32_16x16x32_bf16 v[144:147], v[52:55], v[68:71], v[144:147]
    ds_read_b128 v[112:115], v1 offset:32768
    ds_read_b128 v[116:119], v2 offset:32768
    v_mfma_f32_16x16x32_bf16 v[148:151], v[52:55], v[76:79], v[148:151]
    ds_read_b128 v[120:123], v1 offset:34816
    s_waitcnt lgkmcnt(11)
    ds_read_b128 v[124:127], v2 offset:34816
    v_mfma_f32_16x16x32_bf16 v[152:155], v[52:55], v[84:87], v[152:155]
    v_mfma_f32_16x16x32_bf16 v[156:159], v[52:55], v[92:95], v[156:159]
    v_mfma_f32_16x16x32_bf16 v[160:163], v[56:59], v[68:71], v[160:163]
    v_mfma_f32_16x16x32_bf16 v[164:167], v[56:59], v[76:79], v[164:167]
    v_mfma_f32_16x16x32_bf16 v[168:171], v[56:59], v[84:87], v[168:171]
    s_waitcnt lgkmcnt(0)
    s_add_u32 m0, s6, 16384
    s_lshl_b32 s8, s73, 17
    s_add_u32 s8, s8, s78
    s_add_u32 s8, s8, 32768
    buffer_load_dwordx4 v12, s[48:51], s8 offen offset:0 lds
    v_mfma_f32_16x16x32_bf16 v[172:175], v[56:59], v[92:95], v[172:175]
    buffer_load_dwordx4 v13, s[48:51], s8 offen offset:1024 lds
    buffer_load_dwordx4 v14, s[48:51], s8 offen offset:2048 lds
    buffer_load_dwordx4 v15, s[48:51], s8 offen offset:3072 lds
    v_lshl_add_u32 v20, v20, 8, v8
    v_lshl_add_u32 v21, v21, 8, v9
    v_mfma_f32_16x16x32_bf16 v[176:179], v[60:63], v[68:71], v[176:179]
    v_lshl_add_u32 v22, v22, 8, v10
    v_lshl_add_u32 v23, v23, 8, v11
    s_add_u32 m0, s6, 32768
    s_nop 0
    buffer_load_dwordx4 v20, s[44:47], 0 offen offset:0  lds
    buffer_load_dwordx4 v21, s[44:47], 0 offen offset:1024  lds
    v_mfma_f32_16x16x32_bf16 v[180:183], v[60:63], v[76:79], v[180:183]
    buffer_load_dwordx4 v22, s[44:47], 0 offen offset:2048  lds
    buffer_load_dwordx4 v23, s[44:47], 0 offen offset:3072  lds
    s_lshl_b32 s9, s75, 2
    v_add_u32 v30, s9, v7
    ds_read_b32 v20, v30 offset:3328
    ds_read_b32 v21, v30 offset:4160
    v_mfma_f32_16x16x32_bf16 v[184:187], v[60:63], v[84:87], v[184:187]
    ds_read_b32 v22, v30 offset:4992
    ds_read_b32 v23, v30 offset:5824
    v_mfma_f32_16x16x32_bf16 v[188:191], v[60:63], v[92:95], v[188:191]
    s_cmp_lg_u32 s77, 9
    s_cbranch_scc1 L_nf9
    s_mov_b64 exec, 1
    buffer_store_byte v24, off, s[56:59], s13 sc1
    s_mov_b64 exec, -1
L_nf9:
    v_mfma_f32_16x16x32_bf16 v[192:195], v[32:35], v[96:99], v[192:195]
    s_waitcnt vmcnt(16)
    ds_read_b64_tr_b16 v[48:49], v3 offset:8192
    ds_read_b64_tr_b16 v[50:51], v3 offset:8704
    v_mfma_f32_16x16x32_bf16 v[196:199], v[32:35], v[104:107], v[196:199]
    ds_read_b64_tr_b16 v[52:53], v4 offset:8192
    ds_read_b64_tr_b16 v[54:55], v4 offset:8704
    v_mfma_f32_16x16x32_bf16 v[200:203], v[32:35], v[112:115], v[200:203]
    ds_read_b64_tr_b16 v[56:57], v5 offset:8192
    ds_read_b64_tr_b16 v[58:59], v5 offset:8704
    v_mfma_f32_16x16x32_bf16 v[204:207], v[32:35], v[120:123], v[204:207]
    ds_read_b64_tr_b16 v[60:61], v6 offset:8192
    ds_read_b64_tr_b16 v[62:63], v6 offset:8704
    v_mfma_f32_16x16x32_bf16 v[208:211], v[36:39], v[96:99], v[208:211]
    v_mfma_f32_16x16x32_bf16 v[212:215], v[36:39], v[104:107], v[212:215]
    v_mfma_f32_16x16x32_bf16 v[216:219], v[36:39], v[112:115], v[216:219]
    v_mfma_f32_16x16x32_bf16 v[220:223], v[36:39], v[120:123], v[220:223]
    v_mfma_f32_16x16x32_bf16 v[224:227], v[40:43], v[96:99], v[224:227]
    v_mfma_f32_16x16x32_bf16 v[228:231], v[40:43], v[104:107], v[228:231]
    v_mfma_f32_16x16x32_bf16 v[232:235], v[40:43], v[112:115], v[232:235]
    s_waitcnt lgkmcnt(0)
    s_add_u32 m0, s6, 20480
    v_mfma_f32_16x16x32_bf16 v[236:239], v[40:43], v[120:123], v[236:239]
    s_lshl_b32 s8, s74, 17
    s_add_u32 s8, s8, s79
    v_mfma_f32_16x16x32_bf16 v[240:243], v[44:47], v[96:99], v[240:243]
    buffer_load_dwordx4 v12, s[48:51], s8 offen offset:0 lds
    buffer_load_dwordx4 v13, s[48:51], s8 offen offset:1024 lds
    v_mfma_f32_16x16x32_bf16 v[244:247], v[44:47], v[104:107], v[244:247]
    buffer_load_dwordx4 v14, s[48:51], s8 offen offset:2048 lds
    buffer_load_dwordx4 v15, s[48:51], s8 offen offset:3072 lds
    v_mfma_f32_16x16x32_bf16 v[248:251], v[44:47], v[112:115], v[248:251]
    v_mfma_f32_16x16x32_bf16 v[252:255], v[44:47], v[120:123], v[252:255]
    v_mfma_f32_16x16x32_bf16 v[192:195], v[48:51], v[100:103], v[192:195]
    s_waitcnt vmcnt(16)
    ds_read_b64_tr_b16 v[32:33], v3 offset:12288
    ds_read_b64_tr_b16 v[34:35], v3 offset:12800
    v_mfma_f32_16x16x32_bf16 v[196:199], v[48:51], v[108:111], v[196:199]
    ds_read_b64_tr_b16 v[36:37], v4 offset:12288
    ds_read_b64_tr_b16 v[38:39], v4 offset:12800
    v_mfma_f32_16x16x32_bf16 v[200:203], v[48:51], v[116:119], v[200:203]
    ds_read_b64_tr_b16 v[40:41], v5 offset:12288
    ds_read_b64_tr_b16 v[42:43], v5 offset:12800
    v_mfma_f32_16x16x32_bf16 v[204:207], v[48:51], v[124:127], v[204:207]
    ds_read_b64_tr_b16 v[44:45], v6 offset:12288
    ds_read_b64_tr_b16 v[46:47], v6 offset:12800
    v_mfma_f32_16x16x32_bf16 v[208:211], v[52:55], v[100:103], v[208:211]
    v_mfma_f32_16x16x32_bf16 v[212:215], v[52:55], v[108:111], v[212:215]
    v_mfma_f32_16x16x32_bf16 v[216:219], v[52:55], v[116:119], v[216:219]
    v_mfma_f32_16x16x32_bf16 v[220:223], v[52:55], v[124:127], v[220:223]
    v_mfma_f32_16x16x32_bf16 v[224:227], v[56:59], v[100:103], v[224:227]
    v_mfma_f32_16x16x32_bf16 v[228:231], v[56:59], v[108:111], v[228:231]
    v_mfma_f32_16x16x32_bf16 v[232:235], v[56:59], v[116:119], v[232:235]
    s_waitcnt lgkmcnt(0)
    s_add_u32 m0, s6, 24576
    v_mfma_f32_16x16x32_bf16 v[236:239], v[56:59], v[124:127], v[236:239]
    s_lshl_b32 s8, s74, 17
    s_add_u32 s8, s8, s79
    v_mfma_f32_16x16x32_bf16 v[240:243], v[60:63], v[100:103], v[240:243]
    s_add_u32 s8, s8, 32768
    buffer_load_dwordx4 v12, s[48:51], s8 offen offset:0 lds
    v_mfma_f32_16x16x32_bf16 v[244:247], v[60:63], v[108:111], v[244:247]
    buffer_load_dwordx4 v13, s[48:51], s8 offen offset:1024 lds
    buffer_load_dwordx4 v14, s[48:51], s8 offen offset:2048 lds
    v_mfma_f32_16x16x32_bf16 v[248:251], v[60:63], v[116:119], v[248:251]
    buffer_load_dwordx4 v15, s[48:51], s8 offen offset:3072 lds
    v_mfma_f32_16x16x32_bf16 v[252:255], v[60:63], v[124:127], v[252:255]
    v_mfma_f32_16x16x32_bf16 v[128:131], v[32:35], v[96:99], v[128:131]
    s_waitcnt vmcnt(12)
    ds_read_b64_tr_b16 v[48:49], v3 offset:16384
    ds_read_b64_tr_b16 v[50:51], v3 offset:16896
    v_mfma_f32_16x16x32_bf16 v[132:135], v[32:35], v[104:107], v[132:135]
    ds_read_b64_tr_b16 v[52:53], v4 offset:16384
    ds_read_b64_tr_b16 v[54:55], v4 offset:16896
    v_mfma_f32_16x16x32_bf16 v[136:139], v[32:35], v[112:115], v[136:139]
    ds_read_b64_tr_b16 v[56:57], v5 offset:16384
    ds_read_b64_tr_b16 v[58:59], v5 offset:16896
    v_mfma_f32_16x16x32_bf16 v[140:143], v[32:35], v[120:123], v[140:143]
    ds_read_b64_tr_b16 v[60:61], v6 offset:16384
    ds_read_b64_tr_b16 v[62:63], v6 offset:16896
    v_mfma_f32_16x16x32_bf16 v[144:147], v[36:39], v[96:99], v[144:147]
    ds_read_b128 v[64:67], v1 offset:28672
    ds_read_b128 v[68:71], v2 offset:28672
    v_mfma_f32_16x16x32_bf16 v[148:151], v[36:39], v[104:107], v[148:151]
    ds_read_b128 v[72:75], v1 offset:30720
    ds_read_b128 v[76:79], v2 offset:30720
    v_mfma_f32_16x16x32_bf16 v[152:155], v[36:39], v[112:115], v[152:155]
    v_mfma_f32_16x16x32_bf16 v[156:159], v[36:39], v[120:123], v[156:159]
    v_mfma_f32_16x16x32_bf16 v[160:163], v[40:43], v[96:99], v[160:163]
    v_mfma_f32_16x16x32_bf16 v[164:167], v[40:43], v[104:107], v[164:167]
    v_mfma_f32_16x16x32_bf16 v[168:171], v[40:43], v[112:115], v[168:171]
    s_waitcnt lgkmcnt(0)
    s_add_u32 m0, s6, 0
    s_lshl_b32 s8, s74, 17
    s_add_u32 s8, s8, s78
    buffer_load_dwordx4 v12, s[48:51], s8 offen offset:0 lds
    v_mfma_f32_16x16x32_bf16 v[172:175], v[40:43], v[120:123], v[172:175]
    buffer_load_dwordx4 v13, s[48:51], s8 offen offset:1024 lds
    buffer_load_dwordx4 v14, s[48:51], s8 offen offset:2048 lds
    buffer_load_dwordx4 v15, s[48:51], s8 offen offset:3072 lds
    v_lshl_add_u32 v16, v16, 8, v8
    v_mfma_f32_16x16x32_bf16 v[176:179], v[44:47], v[96:99], v[176:179]
    v_lshl_add_u32 v17, v17, 8, v9
    v_lshl_add_u32 v18, v18, 8, v10
    v_lshl_add_u32 v19, v19, 8, v11
    s_add_u32 m0, s6, 28672
    s_nop 0
    v_mfma_f32_16x16x32_bf16 v[180:183], v[44:47], v[104:107], v[180:183]
    buffer_load_dwordx4 v16, s[44:47], 0 offen offset:0  lds
    buffer_load_dwordx4 v17, s[44:47], 0 offen offset:1024  lds
    buffer_load_dwordx4 v18, s[44:47], 0 offen offset:2048  lds
    buffer_load_dwordx4 v19, s[44:47], 0 offen offset:3072  lds
    s_lshl_b32 s9, s76, 2
    v_mfma_f32_16x16x32_bf16 v[184:187], v[44:47], v[112:115], v[184:187]
    v_add_u32 v30, s9, v7
    ds_read_b32 v16, v30 offset:0
    ds_read_b32 v17, v30 offset:832
    ds_read_b32 v18, v30 offset:1664
    ds_read_b32 v19, v30 offset:2496
    v_mfma_f32_16x16x32_bf16 v[188:191], v[44:47], v[120:123], v[188:191]
    v_mfma_f32_16x16x32_bf16 v[128:131], v[48:51], v[100:103], v[128:131]
    s_waitcnt vmcnt(12)
    ds_read_b64_tr_b16 v[32:33], v3 offset:20480
    ds_read_b64_tr_b16 v[34:35], v3 offset:20992
    v_mfma_f32_16x16x32_bf16 v[132:135], v[48:51], v[108:111], v[132:135]
    ds_read_b64_tr_b16 v[36:37], v4 offset:20480
    ds_read_b64_tr_b16 v[38:39], v4 offset:20992
    v_mfma_f32_16x16x32_bf16 v[136:139], v[48:51], v[116:119], v[136:139]
    ds_read_b64_tr_b16 v[40:41], v5 offset:20480
    ds_read_b64_tr_b16 v[42:43], v5 offset:20992
    v_mfma_f32_16x16x32_bf16 v[140:143], v[48:51], v[124:127], v[140:143]
    ds_read_b64_tr_b16 v[44:45], v6 offset:20480
    ds_read_b64_tr_b16 v[46:47], v6 offset:20992
    v_mfma_f32_16x16x32_bf16 v[144:147], v[52:55], v[100:103], v[144:147]
    ds_read_b128 v[80:83], v1 offset:32768
    ds_read_b128 v[84:87], v2 offset:32768
    v_mfma_f32_16x16x32_bf16 v[148:151], v[52:55], v[108:111], v[148:151]
    ds_read_b128 v[88:91], v1 offset:34816
    s_waitcnt lgkmcnt(11)
    ds_read_b128 v[92:95], v2 offset:34816
    v_mfma_f32_16x16x32_bf16 v[152:155], v[52:55], v[116:119], v[152:155]
    v_mfma_f32_16x16x32_bf16 v[156:159], v[52:55], v[124:127], v[156:159]
    v_mfma_f32_16x16x32_bf16 v[160:163], v[56:59], v[100:103], v[160:163]
    v_mfma_f32_16x16x32_bf16 v[164:167], v[56:59], v[108:111], v[164:167]
    v_mfma_f32_16x16x32_bf16 v[168:171], v[56:59], v[116:119], v[168:171]
    s_waitcnt lgkmcnt(0)
    s_add_u32 m0, s6, 4096
    s_lshl_b32 s8, s74, 17
    s_add_u32 s8, s8, s78
    s_add_u32 s8, s8, 32768
    buffer_load_dwordx4 v12, s[48:51], s8 offen offset:0 lds
    v_mfma_f32_16x16x32_bf16 v[172:175], v[56:59], v[124:127], v[172:175]
    buffer_load_dwordx4 v13, s[48:51], s8 offen offset:1024 lds
    buffer_load_dwordx4 v14, s[48:51], s8 offen offset:2048 lds
    buffer_load_dwordx4 v15, s[48:51], s8 offen offset:3072 lds
    v_lshl_add_u32 v20, v20, 8, v8
    v_lshl_add_u32 v21, v21, 8, v9
    v_mfma_f32_16x16x32_bf16 v[176:179], v[60:63], v[100:103], v[176:179]
    v_lshl_add_u32 v22, v22, 8, v10
    v_lshl_add_u32 v23, v23, 8, v11
    s_add_u32 m0, s6, 32768
    s_nop 0
    buffer_load_dwordx4 v20, s[44:47], 0 offen offset:0  lds
    buffer_load_dwordx4 v21, s[44:47], 0 offen offset:1024  lds
    v_mfma_f32_16x16x32_bf16 v[180:183], v[60:63], v[108:111], v[180:183]
    buffer_load_dwordx4 v22, s[44:47], 0 offen offset:2048  lds
    buffer_load_dwordx4 v23, s[44:47], 0 offen offset:3072  lds
    s_lshl_b32 s9, s76, 2
    v_add_u32 v30, s9, v7
    ds_read_b32 v20, v30 offset:3328
    ds_read_b32 v21, v30 offset:4160
    v_mfma_f32_16x16x32_bf16 v[184:187], v[60:63], v[116:119], v[184:187]
    ds_read_b32 v22, v30 offset:4992
    ds_read_b32 v23, v30 offset:5824
    v_mfma_f32_16x16x32_bf16 v[188:191], v[60:63], v[124:127], v[188:191]
    s_cmp_lg_u32 s77, 10
    s_cbranch_scc1 L_nf10
    s_mov_b64 exec, 1
    buffer_store_byte v24, off, s[56:59], s13 sc1
    s_mov_b64 exec, -1
L_nf10:
    v_mfma_f32_16x16x32_bf16 v[192:195], v[32:35], v[64:67], v[192:195]
    s_waitcnt vmcnt(16)
    ds_read_b64_tr_b16 v[48:49], v3 offset:24576
    ds_read_b64_tr_b16 v[50:51], v3 offset:25088
    v_mfma_f32_16x16x32_bf16 v[196:199], v[32:35], v[72:75], v[196:199]
    ds_read_b64_tr_b16 v[52:53], v4 offset:24576
    ds_read_b64_tr_b16 v[54:55], v4 offset:25088
    v_mfma_f32_16x16x32_bf16 v[200:203], v[32:35], v[80:83], v[200:203]
    ds_read_b64_tr_b16 v[56:57], v5 offset:24576
    ds_read_b64_tr_b16 v[58:59], v5 offset:25088
    v_mfma_f32_16x16x32_bf16 v[204:207], v[32:35], v[88:91], v[204:207]
    ds_read_b64_tr_b16 v[60:61], v6 offset:24576
    ds_read_b64_tr_b16 v[62:63], v6 offset:25088
    v_mfma_f32_16x16x32_bf16 v[208:211], v[36:39], v[64:67], v[208:211]
    v_mfma_f32_16x16x32_bf16 v[212:215], v[36:39], v[72:75], v[212:215]
    v_mfma_f32_16x16x32_bf16 v[216:219], v[36:39], v[80:83], v[216:219]
    v_mfma_f32_16x16x32_bf16 v[220:223], v[36:39], v[88:91], v[220:223]
    v_mfma_f32_16x16x32_bf16 v[224:227], v[40:43], v[64:67], v[224:227]
    v_mfma_f32_16x16x32_bf16 v[228:231], v[40:43], v[72:75], v[228:231]
    v_mfma_f32_16x16x32_bf16 v[232:235], v[40:43], v[80:83], v[232:235]
    s_waitcnt lgkmcnt(0)
    s_add_u32 m0, s6, 8192
    v_mfma_f32_16x16x32_bf16 v[236:239], v[40:43], v[88:91], v[236:239]
    s_lshl_b32 s8, s75, 17
    s_add_u32 s8, s8, s79
    v_mfma_f32_16x16x32_bf16 v[240:243], v[44:47], v[64:67], v[240:243]
    buffer_load_dwordx4 v12, s[48:51], s8 offen offset:0 lds
    buffer_load_dwordx4 v13, s[48:51], s8 offen offset:1024 lds
    v_mfma_f32_16x16x32_bf16 v[244:247], v[44:47], v[72:75], v[244:247]
    buffer_load_dwordx4 v14, s[48:51], s8 offen offset:2048 lds
    buffer_load_dwordx4 v15, s[48:51], s8 offen offset:3072 lds
    v_mfma_f32_16x16x32_bf16 v[248:251], v[44:47], v[80:83], v[248:251]
    v_mfma_f32_16x16x32_bf16 v[252:255], v[44:47], v[88:91], v[252:255]
    v_mfma_f32_16x16x32_bf16 v[192:195], v[48:51], v[68:71], v[192:195]
    s_waitcnt vmcnt(16)
    ds_read_b64_tr_b16 v[32:33], v3 offset:0
    ds_read_b64_tr_b16 v[34:35], v3 offset:512
    v_mfma_f32_16x16x32_bf16 v[196:199], v[48:51], v[76:79], v[196:199]
    ds_read_b64_tr_b16 v[36:37], v4 offset:0
    ds_read_b64_tr_b16 v[38:39], v4 offset:512
    v_mfma_f32_16x16x32_bf16 v[200:203], v[48:51], v[84:87], v[200:203]
    ds_read_b64_tr_b16 v[40:41], v5 offset:0
    ds_read_b64_tr_b16 v[42:43], v5 offset:512
    v_mfma_f32_16x16x32_bf16 v[204:207], v[48:51], v[92:95], v[204:207]
    ds_read_b64_tr_b16 v[44:45], v6 offset:0
    ds_read_b64_tr_b16 v[46:47], v6 offset:512
    v_mfma_f32_16x16x32_bf16 v[208:211], v[52:55], v[68:71], v[208:211]
    v_mfma_f32_16x16x32_bf16 v[212:215], v[52:55], v[76:79], v[212:215]
    v_mfma_f32_16x16x32_bf16 v[216:219], v[52:55], v[84:87], v[216:219]
    v_mfma_f32_16x16x32_bf16 v[220:223], v[52:55], v[92:95], v[220:223]
    v_mfma_f32_16x16x32_bf16 v[224:227], v[56:59], v[68:71], v[224:227]
    v_mfma_f32_16x16x32_bf16 v[228:231], v[56:59], v[76:79], v[228:231]
    v_mfma_f32_16x16x32_bf16 v[232:235], v[56:59], v[84:87], v[232:235]
    s_waitcnt lgkmcnt(0)
    s_add_u32 m0, s6, 12288
    v_mfma_f32_16x16x32_bf16 v[236:239], v[56:59], v[92:95], v[236:239]
    s_lshl_b32 s8, s75, 17
    s_add_u32 s8, s8, s79
    v_mfma_f32_16x16x32_bf16 v[240:243], v[60:63], v[68:71], v[240:243]
    s_add_u32 s8, s8, 32768
    buffer_load_dwordx4 v12, s[48:51], s8 offen offset:0 lds
    v_mfma_f32_16x16x32_bf16 v[244:247], v[60:63], v[76:79], v[244:247]
    buffer_load_dwordx4 v13, s[48:51], s8 offen offset:1024 lds
    buffer_load_dwordx4 v14, s[48:51], s8 offen offset:2048 lds
    v_mfma_f32_16x16x32_bf16 v[248:251], v[60:63], v[84:87], v[248:251]
    buffer_load_dwordx4 v15, s[48:51], s8 offen offset:3072 lds
    v_mfma_f32_16x16x32_bf16 v[252:255], v[60:63], v[92:95], v[252:255]
    v_mfma_f32_16x16x32_bf16 v[128:131], v[32:35], v[64:67], v[128:131]
    s_waitcnt vmcnt(12)
    ds_read_b64_tr_b16 v[48:49], v3 offset:4096
    ds_read_b64_tr_b16 v[50:51], v3 offset:4608
    v_mfma_f32_16x16x32_bf16 v[132:135], v[32:35], v[72:75], v[132:135]
    ds_read_b64_tr_b16 v[52:53], v4 offset:4096
    ds_read_b64_tr_b16 v[54:55], v4 offset:4608
    v_mfma_f32_16x16x32_bf16 v[136:139], v[32:35], v[80:83], v[136:139]
    ds_read_b64_tr_b16 v[56:57], v5 offset:4096
    ds_read_b64_tr_b16 v[58:59], v5 offset:4608
    v_mfma_f32_16x16x32_bf16 v[140:143], v[32:35], v[88:91], v[140:143]
    ds_read_b64_tr_b16 v[60:61], v6 offset:4096
    ds_read_b64_tr_b16 v[62:63], v6 offset:4608
    v_mfma_f32_16x16x32_bf16 v[144:147], v[36:39], v[64:67], v[144:147]
    ds_read_b128 v[96:99], v1 offset:28672
    ds_read_b128 v[100:103], v2 offset:28672
    v_mfma_f32_16x16x32_bf16 v[148:151], v[36:39], v[72:75], v[148:151]
    ds_read_b128 v[104:107], v1 offset:30720
    ds_read_b128 v[108:111], v2 offset:30720
    v_mfma_f32_16x16x32_bf16 v[152:155], v[36:39], v[80:83], v[152:155]
    v_mfma_f32_16x16x32_bf16 v[156:159], v[36:39], v[88:91], v[156:159]
    v_mfma_f32_16x16x32_bf16 v[160:163], v[40:43], v[64:67], v[160:163]
    v_mfma_f32_16x16x32_bf16 v[164:167], v[40:43], v[72:75], v[164:167]
    v_mfma_f32_16x16x32_bf16 v[168:171], v[40:43], v[80:83], v[168:171]
    s_waitcnt lgkmcnt(0)
    s_add_u32 m0, s6, 16384
    s_lshl_b32 s8, s75, 17
    s_add_u32 s8, s8, s78
    v_mfma_f32_16x16x32_bf16 v[172:175], v[40:43], v[88:91], v[172:175]
    buffer_load_dwordx4 v12, s[48:51], s8 offen offset:0 lds
    buffer_load_dwordx4 v13, s[48:51], s8 offen offset:1024 lds
    buffer_load_dwordx4 v14, s[48:51], s8 offen offset:2048 lds
    buffer_load_dwordx4 v15, s[48:51], s8 offen offset:3072 lds
    v_mfma_f32_16x16x32_bf16 v[176:179], v[44:47], v[64:67], v[176:179]
    v_lshl_add_u32 v16, v16, 8, v8
    v_lshl_add_u32 v17, v17, 8, v9
    v_lshl_add_u32 v18, v18, 8, v10
    v_mfma_f32_16x16x32_bf16 v[180:183], v[44:47], v[72:75], v[180:183]
    v_lshl_add_u32 v19, v19, 8, v11
    s_add_u32 m0, s6, 28672
    s_nop 0
    buffer_load_dwordx4 v16, s[44:47], 0 offen offset:0  lds
    v_mfma_f32_16x16x32_bf16 v[184:187], v[44:47], v[80:83], v[184:187]
    buffer_load_dwordx4 v17, s[44:47], 0 offen offset:1024  lds
    buffer_load_dwordx4 v18, s[44:47], 0 offen offset:2048  lds
    buffer_load_dwordx4 v19, s[44:47], 0 offen offset:3072  lds
    v_mfma_f32_16x16x32_bf16 v[188:191], v[44:47], v[88:91], v[188:191]
    v_mfma_f32_16x16x32_bf16 v[128:131], v[48:51], v[68:71], v[128:131]
    s_waitcnt vmcnt(12)
    ds_read_b64_tr_b16 v[32:33], v3 offset:8192
    ds_read_b64_tr_b16 v[34:35], v3 offset:8704
    v_mfma_f32_16x16x32_bf16 v[132:135], v[48:51], v[76:79], v[132:135]
    ds_read_b64_tr_b16 v[36:37], v4 offset:8192
    ds_read_b64_tr_b16 v[38:39], v4 offset:8704
    v_mfma_f32_16x16x32_bf16 v[136:139], v[48:51], v[84:87], v[136:139]
    ds_read_b64_tr_b16 v[40:41], v5 offset:8192
    ds_read_b64_tr_b16 v[42:43], v5 offset:8704
    v_mfma_f32_16x16x32_bf16 v[140:143], v[48:51], v[92:95], v[140:143]
    ds_read_b64_tr_b16 v[44:45], v6 offset:8192
    ds_read_b64_tr_b16 v[46:47], v6 offset:8704
    v_mfma_f32_16x16x32_bf16 v[144:147], v[52:55], v[68:71], v[144:147]
    ds_read_b128 v[112:115], v1 offset:32768
    ds_read_b128 v[116:119], v2 offset:32768
    v_mfma_f32_16x16x32_bf16 v[148:151], v[52:55], v[76:79], v[148:151]
    ds_read_b128 v[120:123], v1 offset:34816
    ds_read_b128 v[124:127], v2 offset:34816
    v_mfma_f32_16x16x32_bf16 v[152:155], v[52:55], v[84:87], v[152:155]
    v_mfma_f32_16x16x32_bf16 v[156:159], v[52:55], v[92:95], v[156:159]
    v_mfma_f32_16x16x32_bf16 v[160:163], v[56:59], v[68:71], v[160:163]
    v_mfma_f32_16x16x32_bf16 v[164:167], v[56:59], v[76:79], v[164:167]
    v_mfma_f32_16x16x32_bf16 v[168:171], v[56:59], v[84:87], v[168:171]
    s_waitcnt lgkmcnt(0)
    s_add_u32 m0, s6, 20480
    s_lshl_b32 s8, s75, 17
    s_add_u32 s8, s8, s78
    v_mfma_f32_16x16x32_bf16 v[172:175], v[56:59], v[92:95], v[172:175]
    s_add_u32 s8, s8, 32768
    buffer_load_dwordx4 v12, s[48:51], s8 offen offset:0 lds
    buffer_load_dwordx4 v13, s[48:51], s8 offen offset:1024 lds
    buffer_load_dwordx4 v14, s[48:51], s8 offen offset:2048 lds
    v_mfma_f32_16x16x32_bf16 v[176:179], v[60:63], v[68:71], v[176:179]
    buffer_load_dwordx4 v15, s[48:51], s8 offen offset:3072 lds
    v_lshl_add_u32 v20, v20, 8, v8
    v_lshl_add_u32 v21, v21, 8, v9
    v_mfma_f32_16x16x32_bf16 v[180:183], v[60:63], v[76:79], v[180:183]
    v_lshl_add_u32 v22, v22, 8, v10
    v_lshl_add_u32 v23, v23, 8, v11
    s_add_u32 m0, s6, 32768
    s_nop 0
    v_mfma_f32_16x16x32_bf16 v[184:187], v[60:63], v[84:87], v[184:187]
    buffer_load_dwordx4 v20, s[44:47], 0 offen offset:0  lds
    buffer_load_dwordx4 v21, s[44:47], 0 offen offset:1024  lds
    buffer_load_dwordx4 v22, s[44:47], 0 offen offset:2048  lds
    buffer_load_dwordx4 v23, s[44:47], 0 offen offset:3072  lds
    v_mfma_f32_16x16x32_bf16 v[188:191], v[60:63], v[92:95], v[188:191]
    v_mfma_f32_16x16x32_bf16 v[192:195], v[32:35], v[96:99], v[192:195]
    s_waitcnt vmcnt(16)
    ds_read_b64_tr_b16 v[48:49], v3 offset:12288
    ds_read_b64_tr_b16 v[50:51], v3 offset:12800
    v_mfma_f32_16x16x32_bf16 v[196:199], v[32:35], v[104:107], v[196:199]
    ds_read_b64_tr_b16 v[52:53], v4 offset:12288
    ds_read_b64_tr_b16 v[54:55], v4 offset:12800
    v_mfma_f32_16x16x32_bf16 v[200:203], v[32:35], v[112:115], v[200:203]
    ds_read_b64_tr_b16 v[56:57], v5 offset:12288
    ds_read_b64_tr_b16 v[58:59], v5 offset:12800
    v_mfma_f32_16x16x32_bf16 v[204:207], v[32:35], v[120:123], v[204:207]
    ds_read_b64_tr_b16 v[60:61], v6 offset:12288
    ds_read_b64_tr_b16 v[62:63], v6 offset:12800
    v_mfma_f32_16x16x32_bf16 v[208:211], v[36:39], v[96:99], v[208:211]
    v_mfma_f32_16x16x32_bf16 v[212:215], v[36:39], v[104:107], v[212:215]
    v_mfma_f32_16x16x32_bf16 v[216:219], v[36:39], v[112:115], v[216:219]
    v_mfma_f32_16x16x32_bf16 v[220:223], v[36:39], v[120:123], v[220:223]
    v_mfma_f32_16x16x32_bf16 v[224:227], v[40:43], v[96:99], v[224:227]
    v_mfma_f32_16x16x32_bf16 v[228:231], v[40:43], v[104:107], v[228:231]
    v_mfma_f32_16x16x32_bf16 v[232:235], v[40:43], v[112:115], v[232:235]
    s_waitcnt lgkmcnt(0)
    s_add_u32 m0, s6, 24576
    v_mfma_f32_16x16x32_bf16 v[236:239], v[40:43], v[120:123], v[236:239]
    s_lshl_b32 s8, s76, 17
    s_add_u32 s8, s8, s79
    v_mfma_f32_16x16x32_bf16 v[240:243], v[44:47], v[96:99], v[240:243]
    buffer_load_dwordx4 v12, s[48:51], s8 offen offset:0 lds
    buffer_load_dwordx4 v13, s[48:51], s8 offen offset:1024 lds
    v_mfma_f32_16x16x32_bf16 v[244:247], v[44:47], v[104:107], v[244:247]
    buffer_load_dwordx4 v14, s[48:51], s8 offen offset:2048 lds
    buffer_load_dwordx4 v15, s[48:51], s8 offen offset:3072 lds
    v_mfma_f32_16x16x32_bf16 v[248:251], v[44:47], v[112:115], v[248:251]
    v_mfma_f32_16x16x32_bf16 v[252:255], v[44:47], v[120:123], v[252:255]
    v_mfma_f32_16x16x32_bf16 v[192:195], v[48:51], v[100:103], v[192:195]
    s_waitcnt vmcnt(16)
    ds_read_b64_tr_b16 v[32:33], v3 offset:16384
    ds_read_b64_tr_b16 v[34:35], v3 offset:16896
    v_mfma_f32_16x16x32_bf16 v[196:199], v[48:51], v[108:111], v[196:199]
    ds_read_b64_tr_b16 v[36:37], v4 offset:16384
    ds_read_b64_tr_b16 v[38:39], v4 offset:16896
    v_mfma_f32_16x16x32_bf16 v[200:203], v[48:51], v[116:119], v[200:203]
    ds_read_b64_tr_b16 v[40:41], v5 offset:16384
    ds_read_b64_tr_b16 v[42:43], v5 offset:16896
    v_mfma_f32_16x16x32_bf16 v[204:207], v[48:51], v[124:127], v[204:207]
    ds_read_b64_tr_b16 v[44:45], v6 offset:16384
    ds_read_b64_tr_b16 v[46:47], v6 offset:16896
    v_mfma_f32_16x16x32_bf16 v[208:211], v[52:55], v[100:103], v[208:211]
    v_mfma_f32_16x16x32_bf16 v[212:215], v[52:55], v[108:111], v[212:215]
    v_mfma_f32_16x16x32_bf16 v[216:219], v[52:55], v[116:119], v[216:219]
    v_mfma_f32_16x16x32_bf16 v[220:223], v[52:55], v[124:127], v[220:223]
    v_mfma_f32_16x16x32_bf16 v[224:227], v[56:59], v[100:103], v[224:227]
    v_mfma_f32_16x16x32_bf16 v[228:231], v[56:59], v[108:111], v[228:231]
    v_mfma_f32_16x16x32_bf16 v[232:235], v[56:59], v[116:119], v[232:235]
    s_waitcnt lgkmcnt(0)
    s_add_u32 m0, s6, 0
    v_mfma_f32_16x16x32_bf16 v[236:239], v[56:59], v[124:127], v[236:239]
    s_lshl_b32 s8, s76, 17
    s_add_u32 s8, s8, s79
    v_mfma_f32_16x16x32_bf16 v[240:243], v[60:63], v[100:103], v[240:243]
    s_add_u32 s8, s8, 32768
    buffer_load_dwordx4 v12, s[48:51], s8 offen offset:0 lds
    v_mfma_f32_16x16x32_bf16 v[244:247], v[60:63], v[108:111], v[244:247]
    buffer_load_dwordx4 v13, s[48:51], s8 offen offset:1024 lds
    buffer_load_dwordx4 v14, s[48:51], s8 offen offset:2048 lds
    v_mfma_f32_16x16x32_bf16 v[248:251], v[60:63], v[116:119], v[248:251]
    buffer_load_dwordx4 v15, s[48:51], s8 offen offset:3072 lds
    v_mfma_f32_16x16x32_bf16 v[252:255], v[60:63], v[124:127], v[252:255]
    v_mfma_f32_16x16x32_bf16 v[128:131], v[32:35], v[96:99], v[128:131]
    s_waitcnt vmcnt(12)
    ds_read_b64_tr_b16 v[48:49], v3 offset:20480
    ds_read_b64_tr_b16 v[50:51], v3 offset:20992
    v_mfma_f32_16x16x32_bf16 v[132:135], v[32:35], v[104:107], v[132:135]
    ds_read_b64_tr_b16 v[52:53], v4 offset:20480
    ds_read_b64_tr_b16 v[54:55], v4 offset:20992
    v_mfma_f32_16x16x32_bf16 v[136:139], v[32:35], v[112:115], v[136:139]
    ds_read_b64_tr_b16 v[56:57], v5 offset:20480
    ds_read_b64_tr_b16 v[58:59], v5 offset:20992
    v_mfma_f32_16x16x32_bf16 v[140:143], v[32:35], v[120:123], v[140:143]
    ds_read_b64_tr_b16 v[60:61], v6 offset:20480
    ds_read_b64_tr_b16 v[62:63], v6 offset:20992
    v_mfma_f32_16x16x32_bf16 v[144:147], v[36:39], v[96:99], v[144:147]
    ds_read_b128 v[64:67], v1 offset:28672
    ds_read_b128 v[68:71], v2 offset:28672
    v_mfma_f32_16x16x32_bf16 v[148:151], v[36:39], v[104:107], v[148:151]
    ds_read_b128 v[72:75], v1 offset:30720
    ds_read_b128 v[76:79], v2 offset:30720
    v_mfma_f32_16x16x32_bf16 v[152:155], v[36:39], v[112:115], v[152:155]
    v_mfma_f32_16x16x32_bf16 v[156:159], v[36:39], v[120:123], v[156:159]
    v_mfma_f32_16x16x32_bf16 v[160:163], v[40:43], v[96:99], v[160:163]
    v_mfma_f32_16x16x32_bf16 v[164:167], v[40:43], v[104:107], v[164:167]
    v_mfma_f32_16x16x32_bf16 v[168:171], v[40:43], v[112:115], v[168:171]
    s_waitcnt lgkmcnt(0)
    s_add_u32 m0, s6, 4096
    v_mfma_f32_16x16x32_bf16 v[172:175], v[40:43], v[120:123], v[172:175]
    s_lshl_b32 s8, s76, 17
    s_add_u32 s8, s8, s78
    v_mfma_f32_16x16x32_bf16 v[176:179], v[44:47], v[96:99], v[176:179]
    buffer_load_dwordx4 v12, s[48:51], s8 offen offset:0 lds
    buffer_load_dwordx4 v13, s[48:51], s8 offen offset:1024 lds
    v_mfma_f32_16x16x32_bf16 v[180:183], v[44:47], v[104:107], v[180:183]
    buffer_load_dwordx4 v14, s[48:51], s8 offen offset:2048 lds
    buffer_load_dwordx4 v15, s[48:51], s8 offen offset:3072 lds
    v_mfma_f32_16x16x32_bf16 v[184:187], v[44:47], v[112:115], v[184:187]
    v_mfma_f32_16x16x32_bf16 v[188:191], v[44:47], v[120:123], v[188:191]
    v_mfma_f32_16x16x32_bf16 v[128:131], v[48:51], v[100:103], v[128:131]
    s_waitcnt vmcnt(8)
    ds_read_b64_tr_b16 v[32:33], v3 offset:24576
    ds_read_b64_tr_b16 v[34:35], v3 offset:25088
    v_mfma_f32_16x16x32_bf16 v[132:135], v[48:51], v[108:111], v[132:135]
    ds_read_b64_tr_b16 v[36:37], v4 offset:24576
    ds_read_b64_tr_b16 v[38:39], v4 offset:25088
    v_mfma_f32_16x16x32_bf16 v[136:139], v[48:51], v[116:119], v[136:139]
    ds_read_b64_tr_b16 v[40:41], v5 offset:24576
    ds_read_b64_tr_b16 v[42:43], v5 offset:25088
    v_mfma_f32_16x16x32_bf16 v[140:143], v[48:51], v[124:127], v[140:143]
    ds_read_b64_tr_b16 v[44:45], v6 offset:24576
    ds_read_b64_tr_b16 v[46:47], v6 offset:25088
    v_mfma_f32_16x16x32_bf16 v[144:147], v[52:55], v[100:103], v[144:147]
    ds_read_b128 v[80:83], v1 offset:32768
    ds_read_b128 v[84:87], v2 offset:32768
    v_mfma_f32_16x16x32_bf16 v[148:151], v[52:55], v[108:111], v[148:151]
    ds_read_b128 v[88:91], v1 offset:34816
    ds_read_b128 v[92:95], v2 offset:34816
    v_mfma_f32_16x16x32_bf16 v[152:155], v[52:55], v[116:119], v[152:155]
    v_mfma_f32_16x16x32_bf16 v[156:159], v[52:55], v[124:127], v[156:159]
    v_mfma_f32_16x16x32_bf16 v[160:163], v[56:59], v[100:103], v[160:163]
    v_mfma_f32_16x16x32_bf16 v[164:167], v[56:59], v[108:111], v[164:167]
    v_mfma_f32_16x16x32_bf16 v[168:171], v[56:59], v[116:119], v[168:171]
    s_waitcnt lgkmcnt(0)
    s_add_u32 m0, s6, 8192
    v_mfma_f32_16x16x32_bf16 v[172:175], v[56:59], v[124:127], v[172:175]
    s_lshl_b32 s8, s76, 17
    s_add_u32 s8, s8, s78
    v_mfma_f32_16x16x32_bf16 v[176:179], v[60:63], v[100:103], v[176:179]
    s_add_u32 s8, s8, 32768
    buffer_load_dwordx4 v12, s[48:51], s8 offen offset:0 lds
    v_mfma_f32_16x16x32_bf16 v[180:183], v[60:63], v[108:111], v[180:183]
    buffer_load_dwordx4 v13, s[48:51], s8 offen offset:1024 lds
    buffer_load_dwordx4 v14, s[48:51], s8 offen offset:2048 lds
    v_mfma_f32_16x16x32_bf16 v[184:187], v[60:63], v[116:119], v[184:187]
    buffer_load_dwordx4 v15, s[48:51], s8 offen offset:3072 lds
    v_mfma_f32_16x16x32_bf16 v[188:191], v[60:63], v[124:127], v[188:191]
    v_mfma_f32_16x16x32_bf16 v[192:195], v[32:35], v[64:67], v[192:195]
    s_waitcnt vmcnt(8)
    ds_read_b64_tr_b16 v[48:49], v3 offset:0
    ds_read_b64_tr_b16 v[50:51], v3 offset:512
    v_mfma_f32_16x16x32_bf16 v[196:199], v[32:35], v[72:75], v[196:199]
    ds_read_b64_tr_b16 v[52:53], v4 offset:0
    ds_read_b64_tr_b16 v[54:55], v4 offset:512
    v_mfma_f32_16x16x32_bf16 v[200:203], v[32:35], v[80:83], v[200:203]
    ds_read_b64_tr_b16 v[56:57], v5 offset:0
    ds_read_b64_tr_b16 v[58:59], v5 offset:512
    v_mfma_f32_16x16x32_bf16 v[204:207], v[32:35], v[88:91], v[204:207]
    ds_read_b64_tr_b16 v[60:61], v6 offset:0
    ds_read_b64_tr_b16 v[62:63], v6 offset:512
    v_mfma_f32_16x16x32_bf16 v[208:211], v[36:39], v[64:67], v[208:211]
    v_mfma_f32_16x16x32_bf16 v[212:215], v[36:39], v[72:75], v[212:215]
    v_mfma_f32_16x16x32_bf16 v[216:219], v[36:39], v[80:83], v[216:219]
    v_mfma_f32_16x16x32_bf16 v[220:223], v[36:39], v[88:91], v[220:223]
    v_mfma_f32_16x16x32_bf16 v[224:227], v[40:43], v[64:67], v[224:227]
    v_mfma_f32_16x16x32_bf16 v[228:231], v[40:43], v[72:75], v[228:231]
    v_mfma_f32_16x16x32_bf16 v[232:235], v[40:43], v[80:83], v[232:235]
    v_mfma_f32_16x16x32_bf16 v[236:239], v[40:43], v[88:91], v[236:239]
    v_mfma_f32_16x16x32_bf16 v[240:243], v[44:47], v[64:67], v[240:243]
    v_mfma_f32_16x16x32_bf16 v[244:247], v[44:47], v[72:75], v[244:247]
    v_mfma_f32_16x16x32_bf16 v[248:251], v[44:47], v[80:83], v[248:251]
    v_mfma_f32_16x16x32_bf16 v[252:255], v[44:47], v[88:91], v[252:255]
    s_waitcnt lgkmcnt(6)
    v_mfma_f32_16x16x32_bf16 v[192:195], v[48:51], v[68:71], v[192:195]
    s_waitcnt vmcnt(4)
    ds_read_b64_tr_b16 v[32:33], v3 offset:4096
    ds_read_b64_tr_b16 v[34:35], v3 offset:4608
    v_mfma_f32_16x16x32_bf16 v[196:199], v[48:51], v[76:79], v[196:199]
    ds_read_b64_tr_b16 v[36:37], v4 offset:4096
    ds_read_b64_tr_b16 v[38:39], v4 offset:4608
    v_mfma_f32_16x16x32_bf16 v[200:203], v[48:51], v[84:87], v[200:203]
    ds_read_b64_tr_b16 v[40:41], v5 offset:4096
    ds_read_b64_tr_b16 v[42:43], v5 offset:4608
    v_mfma_f32_16x16x32_bf16 v[204:207], v[48:51], v[92:95], v[204:207]
    ds_read_b64_tr_b16 v[44:45], v6 offset:4096
    ds_read_b64_tr_b16 v[46:47], v6 offset:4608
    s_waitcnt lgkmcnt(12)
    v_mfma_f32_16x16x32_bf16 v[208:211], v[52:55], v[68:71], v[208:211]
    v_mfma_f32_16x16x32_bf16 v[212:215], v[52:55], v[76:79], v[212:215]
    v_mfma_f32_16x16x32_bf16 v[216:219], v[52:55], v[84:87], v[216:219]
    v_mfma_f32_16x16x32_bf16 v[220:223], v[52:55], v[92:95], v[220:223]
    s_waitcnt lgkmcnt(10)
    v_mfma_f32_16x16x32_bf16 v[224:227], v[56:59], v[68:71], v[224:227]
    v_mfma_f32_16x16x32_bf16 v[228:231], v[56:59], v[76:79], v[228:231]
    v_mfma_f32_16x16x32_bf16 v[232:235], v[56:59], v[84:87], v[232:235]
    v_lshlrev_b32 v28, 4, v27
    v_mfma_f32_16x16x32_bf16 v[236:239], v[56:59], v[92:95], v[236:239]
    v_add_u32 v29, s6, v28
    s_waitcnt lgkmcnt(8)
    v_mfma_f32_16x16x32_bf16 v[240:243], v[60:63], v[68:71], v[240:243]
    v_mfma_f32_16x16x32_bf16 v[244:247], v[60:63], v[76:79], v[244:247]
    v_mfma_f32_16x16x32_bf16 v[248:251], v[60:63], v[84:87], v[248:251]
    v_mfma_f32_16x16x32_bf16 v[252:255], v[60:63], v[92:95], v[252:255]
    s_waitcnt lgkmcnt(6)
    v_mfma_f32_16x16x32_bf16 v[128:131], v[32:35], v[64:67], v[128:131]
    s_waitcnt vmcnt(0)
    ds_read_b64_tr_b16 v[48:49], v3 offset:8192
    ds_read_b64_tr_b16 v[50:51], v3 offset:8704
    v_mfma_f32_16x16x32_bf16 v[132:135], v[32:35], v[72:75], v[132:135]
    ds_read_b64_tr_b16 v[52:53], v4 offset:8192
    ds_read_b64_tr_b16 v[54:55], v4 offset:8704
    v_mfma_f32_16x16x32_bf16 v[136:139], v[32:35], v[80:83], v[136:139]
    ds_read_b64_tr_b16 v[56:57], v5 offset:8192
    ds_read_b64_tr_b16 v[58:59], v5 offset:8704
    v_mfma_f32_16x16x32_bf16 v[140:143], v[32:35], v[88:91], v[140:143]
    ds_read_b64_tr_b16 v[60:61], v6 offset:8192
    ds_read_b64_tr_b16 v[62:63], v6 offset:8704
    s_waitcnt lgkmcnt(12)
    v_mfma_f32_16x16x32_bf16 v[144:147], v[36:39], v[64:67], v[144:147]
    v_mfma_f32_16x16x32_bf16 v[148:151], v[36:39], v[72:75], v[148:151]
    v_mfma_f32_16x16x32_bf16 v[152:155], v[36:39], v[80:83], v[152:155]
    v_mfma_f32_16x16x32_bf16 v[156:159], v[36:39], v[88:91], v[156:159]
    s_waitcnt lgkmcnt(10)
    v_mfma_f32_16x16x32_bf16 v[160:163], v[40:43], v[64:67], v[160:163]
    v_mfma_f32_16x16x32_bf16 v[164:167], v[40:43], v[72:75], v[164:167]
    v_mfma_f32_16x16x32_bf16 v[168:171], v[40:43], v[80:83], v[168:171]
    ds_write_b128 v29, v[192:195] offset:20480
    ds_write_b128 v29, v[196:199] offset:21504
    ds_write_b128 v29, v[200:203] offset:22528
    ds_write_b128 v29, v[204:207] offset:23552
    v_mfma_f32_16x16x32_bf16 v[172:175], v[40:43], v[88:91], v[172:175]
    ds_write_b128 v29, v[208:211] offset:24576
    s_waitcnt lgkmcnt(11)
    ds_write_b128 v29, v[212:215] offset:25600
    ds_write_b128 v29, v[216:219] offset:26624
    ds_write_b128 v29, v[220:223] offset:27648
    v_mfma_f32_16x16x32_bf16 v[176:179], v[44:47], v[64:67], v[176:179]
    ds_write_b128 v29, v[224:227] offset:28672
    s_waitcnt lgkmcnt(11)
    ds_write_b128 v29, v[228:231] offset:29696
    ds_write_b128 v29, v[232:235] offset:30720
    ds_write_b128 v29, v[236:239] offset:31744
    v_mfma_f32_16x16x32_bf16 v[180:183], v[44:47], v[72:75], v[180:183]
    ds_write_b128 v29, v[240:243] offset:32768
    s_waitcnt lgkmcnt(11)
    ds_write_b128 v29, v[244:247] offset:33792
    ds_write_b128 v29, v[248:251] offset:34816
    ds_write_b128 v29, v[252:255] offset:35840
    v_mfma_f32_16x16x32_bf16 v[184:187], v[44:47], v[80:83], v[184:187]
    v_mfma_f32_16x16x32_bf16 v[188:191], v[44:47], v[88:91], v[188:191]
    v_mfma_f32_16x16x32_bf16 v[160:163], v[56:59], v[68:71], v[160:163]
    v_mfma_f32_16x16x32_bf16 v[164:167], v[56:59], v[76:79], v[164:167]
    v_mfma_f32_16x16x32_bf16 v[168:171], v[56:59], v[84:87], v[168:171]
    v_mfma_f32_16x16x32_bf16 v[172:175], v[56:59], v[92:95], v[172:175]
    v_mfma_f32_16x16x32_bf16 v[176:179], v[60:63], v[68:71], v[176:179]
    v_mfma_f32_16x16x32_bf16 v[180:183], v[60:63], v[76:79], v[180:183]
    v_mfma_f32_16x16x32_bf16 v[184:187], v[60:63], v[84:87], v[184:187]
    v_mfma_f32_16x16x32_bf16 v[188:191], v[60:63], v[92:95], v[188:191]
    v_mfma_f32_16x16x32_bf16 v[128:131], v[48:51], v[68:71], v[128:131]
    v_mfma_f32_16x16x32_bf16 v[132:135], v[48:51], v[76:79], v[132:135]
    v_mfma_f32_16x16x32_bf16 v[136:139], v[48:51], v[84:87], v[136:139]
    v_mfma_f32_16x16x32_bf16 v[140:143], v[48:51], v[92:95], v[140:143]
    v_mfma_f32_16x16x32_bf16 v[144:147], v[52:55], v[68:71], v[144:147]
    v_mfma_f32_16x16x32_bf16 v[148:151], v[52:55], v[76:79], v[148:151]
    v_mfma_f32_16x16x32_bf16 v[152:155], v[52:55], v[84:87], v[152:155]
    v_mfma_f32_16x16x32_bf16 v[156:159], v[52:55], v[92:95], v[156:159]
    ds_write_b128 v29, v[160:163] offset:12288
    s_waitcnt lgkmcnt(11)
    ds_write_b128 v29, v[164:167] offset:13312
    ds_write_b128 v29, v[168:171] offset:14336
    ds_write_b128 v29, v[172:175] offset:15360
    ds_write_b128 v29, v[176:179] offset:16384
    s_waitcnt lgkmcnt(11)
    ds_write_b128 v29, v[180:183] offset:17408
    ds_write_b128 v29, v[184:187] offset:18432
    ds_write_b128 v29, v[188:191] offset:19456
    s_xor_b32 s8, s5, 1
    s_mul_i32 s8, s8, 36864
    s_add_u32 s8, s8, 8192
    v_add_u32 v4, s8, v28
    s_xor_b32 s8, s5, 2
    s_mul_i32 s8, s8, 36864
    s_add_u32 s8, s8, 8192
    v_add_u32 v5, s8, v28
    s_xor_b32 s8, s5, 3
    s_mul_i32 s8, s8, 36864
    s_add_u32 s8, s8, 8192
    v_add_u32 v6, s8, v28
    v_lshrrev_b32 v30, 4, v27
    s_lshl_b32 s8, s5, 3
    v_add_u32 v30, s8, v30
    v_lshlrev_b32 v31, 4, v30
    v_lshlrev_b32 v30, 3, v30
    v_lshlrev_b32 v8, 2, v27
    s_lshl_b32 s8, s5, 8
    v_add_u32 v8, s8, v8
    s_waitcnt lgkmcnt(0)
    s_barrier
    ds_read_b128 v[160:163], v4 offset:12288
    ds_read_b128 v[164:167], v4 offset:13312
    ds_read_b128 v[168:171], v4 offset:14336
    ds_read_b128 v[172:175], v4 offset:15360
    ds_read_b128 v[176:179], v4 offset:16384
    ds_read_b128 v[180:183], v4 offset:17408
    ds_read_b128 v[184:187], v4 offset:18432
    ds_read_b128 v[188:191], v4 offset:19456
    ds_read_b128 v[192:195], v5 offset:20480
    ds_read_b128 v[196:199], v5 offset:21504
    ds_read_b128 v[200:203], v5 offset:22528
    ds_read_b128 v[204:207], v5 offset:23552
    ds_read_b128 v[208:211], v5 offset:24576
    ds_read_b128 v[212:215], v5 offset:25600
    ds_read_b128 v[216:219], v5 offset:26624
    s_waitcnt lgkmcnt(11)
    ds_read_b128 v[220:223], v5 offset:27648
    ds_read_b128 v[224:227], v6 offset:28672
    ds_read_b128 v[228:231], v6 offset:29696
    ds_read_b128 v[232:235], v6 offset:30720
    s_waitcnt lgkmcnt(11)
    ds_read_b128 v[236:239], v6 offset:31744
    ds_read_b128 v[240:243], v6 offset:32768
    ds_read_b128 v[244:247], v6 offset:33792
    ds_read_b128 v[248:251], v6 offset:34816
    s_waitcnt lgkmcnt(11)
    ds_read_b128 v[252:255], v6 offset:35840
    ds_read_b128 v[32:35], v31 offset:6656
    ds_read_b64 v[40:41], v30 offset:7168
    ds_read_b128 v[36:39], v31 offset:6720
    s_waitcnt lgkmcnt(11)
    ds_read_b64 v[42:43], v30 offset:7200
    v_pk_add_f32 v[128:129], v[128:129], v[160:161]
    v_pk_add_f32 v[130:131], v[130:131], v[162:163]
    v_pk_add_f32 v[132:133], v[132:133], v[164:165]
    v_pk_add_f32 v[134:135], v[134:135], v[166:167]
    v_pk_add_f32 v[136:137], v[136:137], v[168:169]
    v_pk_add_f32 v[138:139], v[138:139], v[170:171]
    v_pk_add_f32 v[140:141], v[140:141], v[172:173]
    v_pk_add_f32 v[142:143], v[142:143], v[174:175]
    v_pk_add_f32 v[144:145], v[144:145], v[176:177]
    v_pk_add_f32 v[146:147], v[146:147], v[178:179]
    v_pk_add_f32 v[148:149], v[148:149], v[180:181]
    v_pk_add_f32 v[150:151], v[150:151], v[182:183]
    v_pk_add_f32 v[152:153], v[152:153], v[184:185]
    v_pk_add_f32 v[154:155], v[154:155], v[186:187]
    v_pk_add_f32 v[156:157], v[156:157], v[188:189]
    v_pk_add_f32 v[158:159], v[158:159], v[190:191]
    v_pk_add_f32 v[128:129], v[128:129], v[192:193]
    v_pk_add_f32 v[130:131], v[130:131], v[194:195]
    v_pk_add_f32 v[132:133], v[132:133], v[196:197]
    v_pk_add_f32 v[134:135], v[134:135], v[198:199]
    v_pk_add_f32 v[136:137], v[136:137], v[200:201]
    v_pk_add_f32 v[138:139], v[138:139], v[202:203]
    v_pk_add_f32 v[140:141], v[140:141], v[204:205]
    v_pk_add_f32 v[142:143], v[142:143], v[206:207]
    v_pk_add_f32 v[144:145], v[144:145], v[208:209]
    v_pk_add_f32 v[146:147], v[146:147], v[210:211]
    v_pk_add_f32 v[148:149], v[148:149], v[212:213]
    v_pk_add_f32 v[150:151], v[150:151], v[214:215]
    v_pk_add_f32 v[152:153], v[152:153], v[216:217]
    v_pk_add_f32 v[154:155], v[154:155], v[218:219]
    v_pk_add_f32 v[156:157], v[156:157], v[220:221]
    v_pk_add_f32 v[158:159], v[158:159], v[222:223]
    s_waitcnt lgkmcnt(11)
    v_pk_add_f32 v[128:129], v[128:129], v[224:225]
    v_pk_add_f32 v[130:131], v[130:131], v[226:227]
    s_waitcnt lgkmcnt(10)
    v_pk_add_f32 v[132:133], v[132:133], v[228:229]
    v_pk_add_f32 v[134:135], v[134:135], v[230:231]
    s_waitcnt lgkmcnt(9)
    v_pk_add_f32 v[136:137], v[136:137], v[232:233]
    v_pk_add_f32 v[138:139], v[138:139], v[234:235]
    s_waitcnt lgkmcnt(8)
    v_pk_add_f32 v[140:141], v[140:141], v[236:237]
    v_pk_add_f32 v[142:143], v[142:143], v[238:239]
    s_waitcnt lgkmcnt(7)
    v_pk_add_f32 v[144:145], v[144:145], v[240:241]
    v_pk_add_f32 v[146:147], v[146:147], v[242:243]
    s_waitcnt lgkmcnt(6)
    v_pk_add_f32 v[148:149], v[148:149], v[244:245]
    v_pk_add_f32 v[150:151], v[150:151], v[246:247]
    s_waitcnt lgkmcnt(5)
    v_pk_add_f32 v[152:153], v[152:153], v[248:249]
    v_pk_add_f32 v[154:155], v[154:155], v[250:251]
    s_waitcnt lgkmcnt(4)
    v_pk_add_f32 v[156:157], v[156:157], v[252:253]
    v_pk_add_f32 v[158:159], v[158:159], v[254:255]
    v_cvt_pk_bf16_f32 v64, v128, v129
    v_cvt_pk_bf16_f32 v65, v130, v131
    v_cvt_pk_bf16_f32 v66, v132, v133
    v_cvt_pk_bf16_f32 v67, v134, v135
    v_cvt_pk_bf16_f32 v68, v136, v137
    v_cvt_pk_bf16_f32 v69, v138, v139
    v_cvt_pk_bf16_f32 v70, v140, v141
    v_cvt_pk_bf16_f32 v71, v142, v143
    v_cvt_pk_bf16_f32 v72, v144, v145
    v_cvt_pk_bf16_f32 v73, v146, v147
    v_cvt_pk_bf16_f32 v74, v148, v149
    v_cvt_pk_bf16_f32 v75, v150, v151
    v_cvt_pk_bf16_f32 v76, v152, v153
    v_cvt_pk_bf16_f32 v77, v154, v155
    v_cvt_pk_bf16_f32 v78, v156, v157
    v_cvt_pk_bf16_f32 v79, v158, v159
    v_lshlrev_b32 v128, 16, v64
    v_and_b32 v129, 0xffff0000, v64
    v_lshlrev_b32 v130, 16, v65
    v_and_b32 v131, 0xffff0000, v65
    v_lshlrev_b32 v132, 16, v66
    v_and_b32 v133, 0xffff0000, v66
    v_lshlrev_b32 v134, 16, v67
    v_and_b32 v135, 0xffff0000, v67
    v_lshlrev_b32 v136, 16, v68
    v_and_b32 v137, 0xffff0000, v68
    v_lshlrev_b32 v138, 16, v69
    v_and_b32 v139, 0xffff0000, v69
    v_lshlrev_b32 v140, 16, v70
    v_and_b32 v141, 0xffff0000, v70
    v_lshlrev_b32 v142, 16, v71
    v_and_b32 v143, 0xffff0000, v71
    v_lshlrev_b32 v144, 16, v72
    v_and_b32 v145, 0xffff0000, v72
    v_lshlrev_b32 v146, 16, v73
    v_and_b32 v147, 0xffff0000, v73
    v_lshlrev_b32 v148, 16, v74
    v_and_b32 v149, 0xffff0000, v74
    v_lshlrev_b32 v150, 16, v75
    v_and_b32 v151, 0xffff0000, v75
    v_lshlrev_b32 v152, 16, v76
    v_and_b32 v153, 0xffff0000, v76
    v_lshlrev_b32 v154, 16, v77
    v_and_b32 v155, 0xffff0000, v77
    v_lshlrev_b32 v156, 16, v78
    v_and_b32 v157, 0xffff0000, v78
    v_lshlrev_b32 v158, 16, v79
    v_and_b32 v159, 0xffff0000, v79
    s_waitcnt lgkmcnt(0)
    v_mov_b32 v28, 0
    v_mov_b32 v29, 0
    v_mov_b32 v30, 0
    v_mov_b32 v31, 0
    v_pk_add_f32 v[128:129], v[128:129], v[32:33]
    v_pk_add_f32 v[130:131], v[130:131], v[34:35]
    v_pk_add_f32 v[132:133], v[132:133], v[32:33]
    v_pk_add_f32 v[134:135], v[134:135], v[34:35]
    v_pk_add_f32 v[136:137], v[136:137], v[32:33]
    v_pk_add_f32 v[138:139], v[138:139], v[34:35]
    v_pk_add_f32 v[140:141], v[140:141], v[32:33]
    v_pk_add_f32 v[142:143], v[142:143], v[34:35]
    v_pk_add_f32 v[144:145], v[144:145], v[36:37]
    v_pk_add_f32 v[146:147], v[146:147], v[38:39]
    v_pk_add_f32 v[148:149], v[148:149], v[36:37]
    v_pk_add_f32 v[150:151], v[150:151], v[38:39]
    v_pk_add_f32 v[152:153], v[152:153], v[36:37]
    v_pk_add_f32 v[154:155], v[154:155], v[38:39]
    v_pk_add_f32 v[156:157], v[156:157], v[36:37]
    v_pk_add_f32 v[158:159], v[158:159], v[38:39]
    v_cvt_pk_bf16_f32 v64, v128, v129
    v_cvt_pk_bf16_f32 v65, v130, v131
    v_cvt_pk_bf16_f32 v66, v132, v133
    v_cvt_pk_bf16_f32 v67, v134, v135
    v_cvt_pk_bf16_f32 v68, v136, v137
    v_cvt_pk_bf16_f32 v69, v138, v139
    v_cvt_pk_bf16_f32 v70, v140, v141
    v_cvt_pk_bf16_f32 v71, v142, v143
    v_cvt_pk_bf16_f32 v72, v144, v145
    v_cvt_pk_bf16_f32 v73, v146, v147
    v_cvt_pk_bf16_f32 v74, v148, v149
    v_cvt_pk_bf16_f32 v75, v150, v151
    v_cvt_pk_bf16_f32 v76, v152, v153
    v_cvt_pk_bf16_f32 v77, v154, v155
    v_cvt_pk_bf16_f32 v78, v156, v157
    v_cvt_pk_bf16_f32 v79, v158, v159
    v_mov_b32 v96, 0
    v_pk_min_i16 v80, v64, 0
    v_pk_min_i16 v81, v65, 0
    v_pk_min_i16 v82, v66, 0
    v_pk_min_i16 v83, v67, 0
    v_pk_min_i16 v84, v68, 0
    v_pk_min_i16 v85, v69, 0
    v_pk_min_i16 v86, v70, 0
    v_pk_min_i16 v87, v71, 0
    v_pk_min_i16 v88, v72, 0
    v_pk_min_i16 v89, v73, 0
    v_pk_min_i16 v90, v74, 0
    v_pk_min_i16 v91, v75, 0
    v_pk_min_i16 v92, v76, 0
    v_pk_min_i16 v93, v77, 0
    v_pk_min_i16 v94, v78, 0
    v_pk_min_i16 v95, v79, 0
    v_pk_max_i16 v64, v64, 0
    v_pk_max_i16 v65, v65, 0
    v_pk_max_i16 v66, v66, 0
    v_pk_max_i16 v67, v67, 0
    v_pk_max_i16 v68, v68, 0
    v_pk_max_i16 v69, v69, 0
    v_pk_max_i16 v70, v70, 0
    v_pk_max_i16 v71, v71, 0
    v_pk_max_i16 v72, v72, 0
    v_pk_max_i16 v73, v73, 0
    v_pk_max_i16 v74, v74, 0
    v_pk_max_i16 v75, v75, 0
    v_pk_max_i16 v76, v76, 0
    v_pk_max_i16 v77, v77, 0
    v_pk_max_i16 v78, v78, 0
    v_pk_max_i16 v79, v79, 0
    v_dot2c_f32_bf16 v28, v80, v96
    v_dot2c_f32_bf16 v28, v81, v96
    v_dot2c_f32_bf16 v29, v82, v96
    v_dot2c_f32_bf16 v29, v83, v96
    v_dot2c_f32_bf16 v30, v84, v96
    v_dot2c_f32_bf16 v30, v85, v96
    v_dot2c_f32_bf16 v31, v86, v96
    v_dot2c_f32_bf16 v31, v87, v96
    v_dot2c_f32_bf16 v28, v88, v96
    v_dot2c_f32_bf16 v28, v89, v96
    v_dot2c_f32_bf16 v29, v90, v96
    v_dot2c_f32_bf16 v29, v91, v96
    v_dot2c_f32_bf16 v30, v92, v96
    v_dot2c_f32_bf16 v30, v93, v96
    v_dot2c_f32_bf16 v31, v94, v96
    v_dot2c_f32_bf16 v31, v95, v96
    v_dot2c_f32_bf16 v28, v64, v40
    v_dot2c_f32_bf16 v29, v66, v40
    v_dot2c_f32_bf16 v30, v68, v40
    v_dot2c_f32_bf16 v31, v70, v40
    v_dot2c_f32_bf16 v28, v72, v42
    v_dot2c_f32_bf16 v29, v74, v42
    v_dot2c_f32_bf16 v30, v76, v42
    v_dot2c_f32_bf16 v31, v78, v42
    v_dot2c_f32_bf16 v28, v65, v41
    v_dot2c_f32_bf16 v29, v67, v41
    v_dot2c_f32_bf16 v30, v69, v41
    v_dot2c_f32_bf16 v31, v71, v41
    v_dot2c_f32_bf16 v28, v73, v43
    v_dot2c_f32_bf16 v29, v75, v43
    v_dot2c_f32_bf16 v30, v77, v43
    v_dot2c_f32_bf16 v31, v79, v43
    s_nop 3
    v_permlane32_swap_b32 v28, v30
    v_permlane32_swap_b32 v29, v31
    s_nop 1
    v_add_f32 v28, v28, v30
    v_add_f32 v29, v29, v31
    s_nop 1
    v_permlane16_swap_b32 v28, v29
    s_nop 1
    v_add_f32 v28, v28, v29
    ds_write_b32 v8, v28
    s_waitcnt lgkmcnt(0)
    s_barrier
L_fin:
    s_endpgm
L_helper:
    s_lshl_b32 s8, s3, 4
    s_lshl_b32 s9, s4, 2
    s_add_u32 s8, s8, s9
    s_lshl_b32 s8, s8, 8
    v_lshlrev_b32 v28, 4, v27
    v_add_u32 v28, s8, v28
    v_mov_b32 v4, -1
    v_mov_b32 v5, -1
    v_mov_b32 v6, -1
    v_mov_b32 v7, -1
    v_lshlrev_b32 v12, 7, v27
    v_lshlrev_b32 v30, 2, v27
    s_waitcnt lgkmcnt(0)
    s_mov_b32 s52, s38
    s_and_b32 s53, s39, 0xffff
    s_mov_b32 s54, 131072
    s_mov_b32 s55, 0x20000
    s_mov_b32 s48, s26
    s_and_b32 s49, s27, 0xffff
    s_mov_b32 s50, 3407872
    s_mov_b32 s51, 0x20000
    s_mov_b32 s84, s28
    s_and_b32 s85, s29, 0xffff
    s_mov_b32 s86, 1024
    s_mov_b32 s87, 0x20000
    s_mov_b32 s64, s30
    s_and_b32 s65, s31, 0xffff
    s_mov_b32 s66, 1024
    s_mov_b32 s67, 0x20000
    s_mov_b32 s56, s36
    s_and_b32 s57, s37, 0xffff
    s_mov_b32 s58, 256
    s_mov_b32 s59, 0x20000
    s_mov_b32 s44, s18
    s_and_b32 s45, s19, 0xffff
    s_mov_b32 s46, 25600000
    s_mov_b32 s47, 0x20000
    v_lshlrev_b32 v15, 19, v27
    s_lshr_b32 s8, s14, 4
    s_mul_i32 s8, s8, 1703936
    s_and_b32 s9, s14, 15
    s_lshl_b32 s9, s9, 13
    s_add_u32 s8, s8, s9
    v_add_u32 v17, s8, v12
    v_and_b32 v18, 15, v27
    s_lshl_b32 s8, s4, 4
    v_add_u32 v18, s8, v18
    v_mul_u32_u24 v18, 104, v18
    v_lshrrev_b32 v19, 4, v27
    v_and_b32 v19, 1, v19
    v_mul_u32_u24 v19, 52, v19
    v_add_u32 v18, v18, v19
    v_lshrrev_b32 v19, 5, v27
    v_lshlrev_b32 v19, 7, v19
    s_barrier
    s_lshl_b32 s8, s4, 3
    s_lshr_b32 s8, 0x76543210, s8
    s_and_b32 s9, s8, 7
    s_lshr_b32 s8, s8, 4
    s_and_b32 s8, s8, 7
    s_lshl_b32 s9, s9, 7
    s_lshl_b32 s8, s8, 7
    v_and_b32 v21, 31, v27
    v_lshlrev_b32 v21, 2, v21
    v_mov_b32 v22, s9
    v_mov_b32 v23, s8
    v_cmp_gt_u32 vcc, 32, v27
    s_nop 1
    v_cndmask_b32 v22, v23, v22, vcc
    v_add_u32 v21, v21, v22
    buffer_load_dword v80, v21, s[84:87], 0 offen
    buffer_load_dword v81, v21, s[64:67], 0 offen
    s_mov_b32 s80, s32
    s_and_b32 s81, s33, 0xffff
    s_mov_b32 s82, 2
    s_mov_b32 s83, 0x20000
    buffer_load_ushort v83, off, s[80:83], 0
    s_cmp_lg_u32 s4, 0
    s_cbranch_scc1 L_nowide
    s_mov_b32 s68, s20
    s_and_b32 s69, s21, 0xffff
    s_mov_b32 s70, 106496
    s_mov_b32 s71, 0x20000
    s_mov_b32 s72, s22
    s_and_b32 s73, s23, 0xffff
    s_mov_b32 s74, 26
    s_mov_b32 s75, 0x20000
    s_mov_b32 s76, s24
    s_and_b32 s77, s25, 0xffff
    s_mov_b32 s78, 2
    s_mov_b32 s79, 0x20000
    buffer_load_ushort v82, off, s[76:79], 0
    s_lshl_b32 s8, s3, 6
    v_add_u32 v29, s8, v27
    v_mul_u32_u24 v29, 26, v29
    buffer_load_ushort v90, v29, s[68:71], 0 offen offset:0
    buffer_load_ushort v110, off, s[72:75], 0 offset:0
    buffer_load_ushort v91, v29, s[68:71], 0 offen offset:2
    buffer_load_ushort v111, off, s[72:75], 0 offset:2
    buffer_load_ushort v92, v29, s[68:71], 0 offen offset:4
    buffer_load_ushort v112, off, s[72:75], 0 offset:4
    buffer_load_ushort v93, v29, s[68:71], 0 offen offset:6
    buffer_load_ushort v113, off, s[72:75], 0 offset:6
    buffer_load_ushort v94, v29, s[68:71], 0 offen offset:8
    buffer_load_ushort v114, off, s[72:75], 0 offset:8
    buffer_load_ushort v95, v29, s[68:71], 0 offen offset:10
    buffer_load_ushort v115, off, s[72:75], 0 offset:10
    buffer_load_ushort v96, v29, s[68:71], 0 offen offset:12
    buffer_load_ushort v116, off, s[72:75], 0 offset:12
    buffer_load_ushort v97, v29, s[68:71], 0 offen offset:14
    buffer_load_ushort v117, off, s[72:75], 0 offset:14
    buffer_load_ushort v98, v29, s[68:71], 0 offen offset:16
    buffer_load_ushort v118, off, s[72:75], 0 offset:16
    buffer_load_ushort v99, v29, s[68:71], 0 offen offset:18
    buffer_load_ushort v119, off, s[72:75], 0 offset:18
    buffer_load_ushort v100, v29, s[68:71], 0 offen offset:20
    buffer_load_ushort v120, off, s[72:75], 0 offset:20
    buffer_load_ushort v101, v29, s[68:71], 0 offen offset:22
    buffer_load_ushort v121, off, s[72:75], 0 offset:22
    buffer_load_ushort v102, v29, s[68:71], 0 offen offset:24
    buffer_load_ushort v122, off, s[72:75], 0 offset:24
L_nowide:
    s_barrier
    s_waitcnt vmcnt(0)
    v_lshlrev_b32 v84, 16, v80
    v_and_b32 v85, 0xffff0000, v80
    v_lshlrev_b32 v29, 3, v27
    ds_write_b64 v29, v[84:85] offset:6656
    ds_write_b32 v30, v81 offset:7168
    v_lshlrev_b32 v83, 16, v83
    v_mov_b32 v87, 0
    s_cmp_lg_u32 s4, 0
    s_cbranch_scc1 L_hdone
    v_lshlrev_b32 v82, 16, v82
    v_lshlrev_b32 v90, 16, v90
    v_lshlrev_b32 v110, 16, v110
    v_fmac_f32 v87, v90, v110
    v_lshlrev_b32 v91, 16, v91
    v_lshlrev_b32 v111, 16, v111
    v_fmac_f32 v87, v91, v111
    v_lshlrev_b32 v92, 16, v92
    v_lshlrev_b32 v112, 16, v112
    v_fmac_f32 v87, v92, v112
    v_lshlrev_b32 v93, 16, v93
    v_lshlrev_b32 v113, 16, v113
    v_fmac_f32 v87, v93, v113
    v_lshlrev_b32 v94, 16, v94
    v_lshlrev_b32 v114, 16, v114
    v_fmac_f32 v87, v94, v114
    v_lshlrev_b32 v95, 16, v95
    v_lshlrev_b32 v115, 16, v115
    v_fmac_f32 v87, v95, v115
    v_lshlrev_b32 v96, 16, v96
    v_lshlrev_b32 v116, 16, v116
    v_fmac_f32 v87, v96, v116
    v_lshlrev_b32 v97, 16, v97
    v_lshlrev_b32 v117, 16, v117
    v_fmac_f32 v87, v97, v117
    v_lshlrev_b32 v98, 16, v98
    v_lshlrev_b32 v118, 16, v118
    v_fmac_f32 v87, v98, v118
    v_lshlrev_b32 v99, 16, v99
    v_lshlrev_b32 v119, 16, v119
    v_fmac_f32 v87, v99, v119
    v_lshlrev_b32 v100, 16, v100
    v_lshlrev_b32 v120, 16, v120
    v_fmac_f32 v87, v100, v120
    v_lshlrev_b32 v101, 16, v101
    v_lshlrev_b32 v121, 16, v121
    v_fmac_f32 v87, v101, v121
    v_lshlrev_b32 v102, 16, v102
    v_lshlrev_b32 v122, 16, v122
    v_fmac_f32 v87, v102, v122
    v_cvt_pk_bf16_f32 v87, v87, v87
    v_lshlrev_b32 v87, 16, v87
    v_add_f32 v87, v87, v82
    v_cvt_pk_bf16_f32 v87, v87, v87
    v_lshlrev_b32 v87, 16, v87
L_hdone:
    s_mov_b32 s68, s34
    s_and_b32 s69, s35, 0xffff
    s_mov_b32 s70, 8192
    s_mov_b32 s71, 0x20000
    s_lshl_b32 s15, s3, 2
    s_lshl_b32 s12, s3, 11
    s_lshl_b32 s8, s4, 9
    s_add_u32 s13, s12, s8
    s_lshl_b32 s10, s3, 7
    v_lshlrev_b32 v31, 1, v27
    s_cmp_eq_u32 s4, 0
    s_cselect_b64 s[92:93], -1, 0
    s_cmp_eq_u32 s4, 1
    s_cselect_b64 s[94:95], -1, 0
    s_cmp_eq_u32 s4, 2
    s_cselect_b64 s[96:97], -1, 0
    s_cmp_eq_u32 s4, 3
    s_cselect_b64 s[98:99], -1, 0
    s_mov_b32 s11, 0
    s_mov_b32 s9, 0
    s_waitcnt lgkmcnt(0)
    s_barrier
L_look:
    v_mov_b32 v40, -1
    v_mov_b32 v41, -1
    v_mov_b32 v42, -1
    v_mov_b32 v43, -1
    v_mov_b32 v44, -1
    v_mov_b32 v45, -1
    v_mov_b32 v46, -1
    v_mov_b32 v47, -1
    s_cmp_eq_u32 s9, 0x01010101
    s_cbranch_scc1 L_slots
    buffer_load_dword v60, off, s[56:59], s15 sc1
    s_waitcnt vmcnt(0)
    v_readfirstlane_b32 s9, v60
    s_cmp_lg_u32 s9, 0x01010101
    s_cbranch_scc1 L_noslots
L_slots:
    buffer_load_dwordx2 v[40:41], v29, s[52:55], s12 offen offset:0 sc1
    buffer_load_dwordx2 v[42:43], v29, s[52:55], s12 offen offset:512 sc1
    buffer_load_dwordx2 v[44:45], v29, s[52:55], s12 offen offset:1024 sc1
    buffer_load_dwordx2 v[46:47], v29, s[52:55], s12 offen offset:1536 sc1
L_noslots:
    s_cmp_lg_u32 s11, 0
    s_cbranch_scc1 L_have
    s_barrier
    ds_read_b32 v50, v30 offset:0
    ds_read_b32 v51, v30 offset:256
    ds_read_b32 v52, v30 offset:512
    ds_read_b32 v53, v30 offset:768
    s_waitcnt lgkmcnt(0)
    v_add_f32 v86, v50, v51
    v_add_f32 v86, v86, v52
    v_add_f32 v86, v86, v53
    v_min_u32 v86, 0xfffffffe, v86
    v_min_u32 v87, 0xfffffffe, v87
L_have:
    s_waitcnt vmcnt(0)
    v_cndmask_b32 v40, v40, v86, s[92:93]
    v_cndmask_b32 v41, v41, v87, s[92:93]
    v_cndmask_b32 v42, v42, v86, s[94:95]
    v_cndmask_b32 v43, v43, v87, s[94:95]
    v_cndmask_b32 v44, v44, v86, s[96:97]
    v_cndmask_b32 v45, v45, v87, s[96:97]
    v_cndmask_b32 v46, v46, v86, s[98:99]
    v_cndmask_b32 v47, v47, v87, s[98:99]
    v_max3_u32 v61, v40, v41, v42
    v_max3_u32 v61, v61, v43, v44
    v_max3_u32 v61, v61, v45, v46
    v_max_u32 v61, v61, v47
    v_cmp_eq_u32 vcc, -1, v61
    s_cbranch_vccz L_final
    s_cmp_lg_u32 s11, 0
    s_cbranch_scc1 L_hend
    buffer_store_dwordx2 v[86:87], v29, s[52:55], s13 offen sc1
    s_mov_b32 s11, 1
    s_waitcnt vmcnt(0)
    s_branch L_look
L_final:
    v_add_f32 v40, v40, v42
    v_add_f32 v40, v40, v44
    v_add_f32 v40, v40, v46
    v_cvt_pk_bf16_f32 v40, v40, v40
    v_lshlrev_b32 v40, 16, v40
    v_add_f32 v40, v40, v83
    v_cvt_pk_bf16_f32 v40, v40, v40
    v_lshlrev_b32 v40, 16, v40
    v_add_f32 v40, v40, v41
    v_cvt_pk_bf16_f32 v40, v40, v40
    v_lshlrev_b32 v40, 16, v40
    v_mul_f32 v40, 0xbfb8aa3b, v40
    v_exp_f32 v40, v40
    s_nop 0
    v_add_f32 v40, 1.0, v40
    v_rcp_f32 v40, v40
    s_nop 0
    v_cvt_pk_bf16_f32 v40, v40, v40
    buffer_store_short v40, v31, s[68:71], s10 offen
L_hend:
L_end:
s_endpgm
.section .rodata,"a"
.p2align 6
.amdhsa_kernel standalone__deep_cross_wide_deep__recsys_kernel
  .amdhsa_next_free_vgpr 256
  .amdhsa_next_free_sgpr 102
  .amdhsa_accum_offset 256
  .amdhsa_group_segment_fixed_size 0
  .amdhsa_kernarg_size 96
  .amdhsa_user_sgpr_count 2
  .amdhsa_user_sgpr_kernarg_segment_ptr 1
  .amdhsa_system_sgpr_workgroup_id_x 1
.end_amdhsa_kernel
```
